```python
import torch

def _softmax(x, axis=-1):
    return torch.softmax(x, dim=axis)
def _gelu(x):
    return torch.nn.functional.gelu(x, approximate="tanh")
def _silu(x):
    return torch.nn.functional.silu(x)
def _sigmoid(x):
    return torch.sigmoid(x)
def _layernorm(x, axis=-1, eps=1e-5):
    m = x.mean(dim=axis, keepdim=True)
    v = x.var(dim=axis, keepdim=True, unbiased=False)
    return (x - m) / torch.sqrt(v + eps)
def _scatter_add(tgt, idx, src, axis=0):
    return tgt.clone().index_add_(axis, idx, src)
def _segment_sum(src, seg, n):
    out = torch.zeros((n,) + src.shape[1:], dtype=src.dtype)
    return out.index_add_(0, seg, src)
def _pad(x, pw):
    flat = tuple(v for pair in reversed(pw) for v in pair)
    return torch.nn.functional.pad(x, flat)

kernel_name = 'gated_mix__sliding_block__mixer_token_mlp__prompt'

def setup_inputs():

    _w = (lambda a: (lambda t: t.to(torch.bfloat16) if t.is_floating_point() else t)(torch.as_tensor(a)))
    def _A_setup():
        B, S, D = 1, 2048, 512
        return {
            "x": _w((lambda *s: torch.randn(*s, dtype=torch.bfloat16) * 0.05)(B, S, D)),
            "wqkv": _w((lambda *s: torch.randn(*s, dtype=torch.bfloat16) * 0.8)(D, 3 * D)),
            "wo": _w((lambda *s: torch.randn(*s, dtype=torch.bfloat16) * 0.05)(D, D)),
        }
    _A_in = _A_setup()

    def _B_setup():
        B, S, D, F = 1, 2048, 512, 1376
        return {
            "x": _w((lambda *s: torch.randn(*s, dtype=torch.bfloat16) * 0.05)(B, S, D)),
            "w1": _w((lambda *s: torch.randn(*s, dtype=torch.bfloat16) * 3.2)(S, F) * (S ** -0.5)),
            "b1": _w((lambda *s: torch.randn(*s, dtype=torch.bfloat16) * 3.2)(F) * 0.02),
            "w2": _w((lambda *s: torch.randn(*s, dtype=torch.bfloat16) * 0.1)(F, S) * (F ** -0.5)),
            "b2": _w((lambda *s: torch.randn(*s, dtype=torch.bfloat16) * 0.1)(S) * 0.02),
        }
    _B_in = _B_setup()

    return {
        "A_x": _A_in["x"],
        "A_wqkv": _A_in["wqkv"],
        "A_wo": _A_in["wo"],
        "B_x": _B_in["x"],
        "B_w1": _B_in["w1"],
        "B_b1": _B_in["b1"],
        "B_w2": _B_in["w2"],
        "B_b2": _B_in["b2"],
        "gate_w": _w((lambda *s: torch.randn(*s, dtype=torch.bfloat16) * 0.05)(512) * 16.0),
    }

def reference(A_x, A_wqkv, A_wo, B_x, B_w1, B_b1, B_w2, B_b2, gate_w):
    def _A_ref(x, wqkv, wo):
        B, S, D = x.shape
        H = 32; Dh = D // H; W = 256
        qkv = (lambda x, *d: x.permute(*d))((x @ wqkv).reshape(B, S, 3, H, Dh), 2, 0, 3, 1, 4)
        q, k, v = qkv[0], qkv[1], qkv[2]
        scores = torch.einsum("bhqd,bhkd->bhqk", q, k) * (Dh ** -0.5)
        idx = torch.arange(S)
        mask = (idx[:, None] - idx[None, :] >= 0) & (idx[:, None] - idx[None, :] < W)
        scores = torch.where(mask[None, None], scores, -1e9)
        p = _softmax(scores, axis=-1)
        o = torch.einsum("bhqk,bhkd->bhqd", p, v)
        return (lambda x, *d: x.permute(*d))(o, 0, 2, 1, 3).reshape(B, S, D) @ wo

    def _B_ref(x, w1, b1, w2, b2):
        B, S, D = x.shape
        h = _layernorm(x, axis=-1)
        u = torch.einsum("bsd,sf->bdf", h, w1) + b1
        u = _gelu(u)
        y = torch.einsum("bdf,fs->bds", u, w2) + b2
        return (lambda x, *d: x.permute(*d))(y, 0, 2, 1)

    x = A_x
    g = _sigmoid((x * gate_w).sum(-1, keepdims=True))
    a = _A_ref(x, A_wqkv, A_wo)
    b = _B_ref(x, B_w1, B_b1, B_w2, B_b2)
    return g * a + (1 - g) * b
```

```asm
; @launch grid=(256,1,1) block=(512,1,1) lds=155904
.amdgcn_target "amdgcn-amd-amdhsa--gfx950"
.text
.globl gated_mix__sliding_block__mixer_token_mlp__prompt_kernel
.p2align 8
.type gated_mix__sliding_block__mixer_token_mlp__prompt_kernel,@function
gated_mix__sliding_block__mixer_token_mlp__prompt_kernel:
  s_cmp_ge_u32 s2, 256
  s_cbranch_scc1 L_end
  s_load_dwordx16 s[40:55], s[0:1], 0
  s_load_dwordx8 s[56:63], s[0:1], 64
  v_lshrrev_b32 v1, 6, v0
  v_and_b32 v2, 63, v0
  v_mov_b32 v252, 0
  v_mov_b32 v251, 155648
  v_readfirstlane_b32 s3, v1
  v_lshlrev_b32 v4, 2, v2
  v_add_u32 v4, 155648, v4
  ds_write_b32 v4, v252
  s_and_b32 s81, s2, 7
  s_lshr_b32 s82, s2, 3
  s_waitcnt lgkmcnt(0)
  s_barrier
  s_mov_b32 s12, s62
  s_and_b32 s13, s63, 0xffff
  s_mov_b32 s14, 0x1000000
  s_mov_b32 s15, 0x00020000
  s_mov_b32 s64, s60
  s_and_b32 s65, s61, 0xffff
  s_mov_b32 s66, 0x100
  s_mov_b32 s67, 0x00020000
  s_cmp_ge_u32 s3, 4
  s_cbranch_scc1 L_attn
  s_mov_b32 s4, s40
  s_and_b32 s5, s41, 0xffff
  s_mov_b32 s6, 0x200000
  s_mov_b32 s7, 0x00020000
  s_mov_b32 s36, s56
  s_and_b32 s37, s57, 0xffff
  s_mov_b32 s38, 0x400
  s_mov_b32 s39, 0x00020000
  s_cmp_ge_u32 s2, 192
  s_cbranch_scc0 L_g_noearly
  s_sub_u32 s90, s2, 192
  v_lshrrev_b32 v200, 3, v2
  v_and_b32 v201, 7, v2
  s_lshl_b32 s83, s90, 5
  s_lshl_b32 s84, s3, 3
  s_add_u32 s83, s83, s84
  v_add_u32 v200, s83, v200
  v_lshlrev_b32 v201, 4, v201
  v_lshl_add_u32 v200, v200, 10, v201
  buffer_load_dwordx4 v[16:19], v200, s[4:7], 0 offen offset:0
  buffer_load_dwordx4 v[20:23], v200, s[4:7], 0 offen offset:128
  buffer_load_dwordx4 v[24:27], v200, s[4:7], 0 offen offset:256
  buffer_load_dwordx4 v[28:31], v200, s[4:7], 0 offen offset:384
  buffer_load_dwordx4 v[32:35], v200, s[4:7], 0 offen offset:512
  buffer_load_dwordx4 v[36:39], v200, s[4:7], 0 offen offset:640
  buffer_load_dwordx4 v[40:43], v200, s[4:7], 0 offen offset:768
  buffer_load_dwordx4 v[44:47], v200, s[4:7], 0 offen offset:896
  buffer_load_dwordx4 v[48:51], v201, s[36:39], 0 offen offset:0
  buffer_load_dwordx4 v[52:55], v201, s[36:39], 0 offen offset:128
  buffer_load_dwordx4 v[56:59], v201, s[36:39], 0 offen offset:256
  buffer_load_dwordx4 v[60:63], v201, s[36:39], 0 offen offset:384
  buffer_load_dwordx4 v[64:67], v201, s[36:39], 0 offen offset:512
  buffer_load_dwordx4 v[68:71], v201, s[36:39], 0 offen offset:640
  buffer_load_dwordx4 v[72:75], v201, s[36:39], 0 offen offset:768
  buffer_load_dwordx4 v[76:79], v201, s[36:39], 0 offen offset:896
  buffer_load_dwordx2 v[144:145], v252, s[64:67], 0 offen sc1
L_g_noearly:
  s_mov_b32 s16, s48
  s_and_b32 s17, s49, 0xffff
  s_mov_b32 s18, 0x560000
  s_mov_b32 s19, 0x00020000
  s_mov_b32 s20, s52
  s_and_b32 s21, s53, 0xffff
  s_mov_b32 s22, 0x560000
  s_mov_b32 s23, 0x00020000
  s_mov_b32 s24, s44
  s_and_b32 s25, s45, 0xffff
  s_mov_b32 s26, 0x80000
  s_mov_b32 s27, 0x00020000
  s_add_u32 s28, s62, 0xb00000
  s_addc_u32 s29, s63, 0
  s_and_b32 s29, s29, 0xffff
  s_mov_b32 s30, 0x158000
  s_mov_b32 s31, 0x00020000
  s_mov_b32 s32, s58
  s_and_b32 s33, s59, 0xffff
  s_mov_b32 s34, 0x200000
  s_mov_b32 s35, 0x00020000
  s_and_b32 s83, s81, 3
  s_mul_i32 s83, s83, 22
  s_add_u32 s83, s83, s82
  s_lshr_b32 s70, s83, 2
  s_lshr_b32 s84, s81, 2
  s_lshl_b32 s84, s84, 2
  s_and_b32 s83, s83, 3
  s_add_u32 s71, s84, s83
  s_lshl_b32 s72, s81, 2
  s_and_b32 s83, s82, 3
  s_add_u32 s72, s72, s83
  s_lshr_b32 s73, s82, 2
  s_mul_i32 s74, s3, 10240
  s_lshl_b32 s76, s3, 13
  s_add_u32 s76, s76, 106496
  s_lshl_b32 s77, s3, 14
  s_add_u32 s77, s77, 40960
  v_lshlrev_b32 v250, 4, v2
  v_lshrrev_b32 v7, 3, v2
  v_and_b32 v8, 7, v2
  v_bfe_u32 v9, v7, 1, 1
  v_lshlrev_b32 v9, 2, v9
  v_xor_b32 v8, v8, v9
  v_lshlrev_b32 v8, 4, v8
  s_movk_i32 s83, 2752
  v_mul_lo_u32 v9, v7, s83
  v_add_u32 v9, v9, v8
  s_mul_i32 s83, s3, 1409024
  s_lshl_b32 s84, s70, 7
  s_add_u32 s83, s83, s84
  v_add_u32 v240, s83, v9
  v_add_u32 v241, 22016, v240
  s_mul_i32 s42, s82, 3
  s_lshr_b32 s42, s42, 1
  s_and_b32 s42, s42, 31
  s_mov_b32 s43, s42
  s_cmp_lt_u32 s2, 176
  s_cbranch_scc0 L_g_nopf
  s_mul_i32 s87, s42, 44032
  s_add_u32 m0, s74, 0
  s_add_u32 s42, s42, 1
  buffer_load_dwordx4 v240, s[16:19], s87 offen lds
  s_add_u32 m0, s74, 1024
  s_and_b32 s42, s42, 31
  buffer_load_dwordx4 v241, s[16:19], s87 offen lds
  s_mul_i32 s87, s42, 44032
  s_add_u32 m0, s74, 2048
  s_add_u32 s42, s42, 1
  buffer_load_dwordx4 v240, s[16:19], s87 offen lds
  s_add_u32 m0, s74, 3072
  s_and_b32 s42, s42, 31
  buffer_load_dwordx4 v241, s[16:19], s87 offen lds
  s_mul_i32 s87, s42, 44032
  s_add_u32 m0, s74, 4096
  s_add_u32 s42, s42, 1
  buffer_load_dwordx4 v240, s[16:19], s87 offen lds
  s_add_u32 m0, s74, 5120
  s_and_b32 s42, s42, 31
  buffer_load_dwordx4 v241, s[16:19], s87 offen lds
  s_mul_i32 s87, s42, 44032
  s_add_u32 m0, s74, 6144
  s_add_u32 s42, s42, 1
  buffer_load_dwordx4 v240, s[16:19], s87 offen lds
  s_add_u32 m0, s74, 7168
  s_and_b32 s42, s42, 31
  buffer_load_dwordx4 v241, s[16:19], s87 offen lds
  s_mul_i32 s87, s42, 44032
  s_add_u32 m0, s74, 8192
  s_add_u32 s42, s42, 1
  buffer_load_dwordx4 v240, s[16:19], s87 offen lds
  s_add_u32 m0, s74, 9216
  s_and_b32 s42, s42, 31
  buffer_load_dwordx4 v241, s[16:19], s87 offen lds
L_g_nopf:
  s_mul_i32 s83, s3, 1441792
  s_lshl_b32 s84, s72, 7
  s_add_u32 s83, s83, s84
  v_lshl_add_u32 v9, v7, 12, v8
  v_add_u32 v242, s83, v9
  v_add_u32 v243, 0x8000, v242
  s_lshl_b32 s83, s3, 17
  s_lshl_b32 s84, s73, 7
  s_add_u32 s83, s83, s84
  v_lshl_add_u32 v9, v7, 10, v8
  v_add_u32 v244, s83, v9
  v_add_u32 v245, 0x2000, v244
  v_and_b32 v7, 15, v2
  v_lshrrev_b32 v8, 2, v7
  v_lshrrev_b32 v9, 5, v2
  v_lshl_add_u32 v9, v9, 2, v8
  v_lshlrev_b32 v10, 7, v9
  v_bfe_u32 v9, v9, 1, 1
  v_lshl_add_u32 v10, v9, 6, v10
  v_bfe_u32 v9, v2, 4, 1
  v_lshl_add_u32 v10, v9, 5, v10
  v_and_b32 v7, 3, v7
  v_lshl_add_u32 v10, v7, 3, v10
  v_xor_b32 v11, 64, v10
  v_add_u32 v246, s74, v10
  v_add_u32 v247, s74, v11
  v_add_u32 v232, s76, v10
  v_add_u32 v233, s76, v11
  v_add_u32 v234, s77, v10
  v_add_u32 v235, s77, v11
  s_and_b32 s44, s82, 3
  s_lshl_b32 s44, s44, 1
  s_lshr_b32 s45, s82, 2
  s_add_u32 s44, s44, s45
  s_and_b32 s44, s44, 7
  s_mov_b32 s45, s44
  s_mul_i32 s46, s82, 22
  s_lshr_b32 s46, s46, 5
  s_mov_b32 s47, s46
  s_cmp_ge_u32 s2, 192
  s_cbranch_scc1 L_ln
  s_mov_b32 s97, 0
L_tok_1:
  buffer_load_dwordx2 v[4:5], v252, s[64:67], 0 offen sc1
  s_waitcnt vmcnt(0)
  v_readfirstlane_b32 s68, v4
  v_readfirstlane_b32 s69, v5
  s_add_u32 s97, s97, 1
  s_cmp_lg_u32 s68, 0
  s_cbranch_scc1 L_tokd_2
  s_cmp_gt_u32 s97, 60000
  s_cbranch_scc1 L_tokd_2
  s_sleep 1
  s_branch L_tok_1
L_tokd_2:
  s_cmp_lt_u32 s2, 176
  s_cbranch_scc0 L_nou
  s_mov_b32 s36, s50
  s_and_b32 s37, s51, 0xffff
  s_mov_b32 s38, 0xac0
  s_mov_b32 s39, 0x00020000
  v_and_b32 v3, 15, v2
  s_lshl_b32 s83, s3, 4
  v_add_u32 v3, s83, v3
  v_lshlrev_b32 v3, 2, v3
  s_lshr_b32 s83, s71, 1
  v_add_u32 v3, s83, v3
  v_lshlrev_b32 v3, 6, v3
  v_add_u32 v3, 0xd00000, v3
  buffer_load_dwordx2 v[4:5], v3, s[12:15], 0 offen sc1
  s_lshl_b32 s83, s71, 18
  s_lshl_b32 s84, s3, 15
  s_add_u32 s83, s83, s84
  s_add_u32 s83, s83, 0x600000
  v_add_u32 v6, s83, v250
  v_add_u32 v7, 0x20000, v6
  v_lshrrev_b32 v8, 5, v2
  v_lshlrev_b32 v8, 3, v8
  s_lshl_b32 s83, s70, 7
  s_and_b32 s84, s3, 1
  s_lshl_b32 s84, s84, 6
  s_add_u32 s83, s83, s84
  v_add_u32 v8, s83, v8
  buffer_load_dwordx2 v[224:225], v8, s[36:39], 0 offen offset:0
  buffer_load_dwordx2 v[226:227], v8, s[36:39], 0 offen offset:16
  buffer_load_dwordx2 v[228:229], v8, s[36:39], 0 offen offset:32
  buffer_load_dwordx2 v[230:231], v8, s[36:39], 0 offen offset:48
  s_waitcnt vmcnt(4)
  s_mov_b32 s97, 0
  v_cmp_eq_u64 vcc, s[68:69], v[4:5]
  s_cmp_eq_u64 vcc, exec
  s_cbranch_scc1 L_fld_6
  s_andn2_b64 s[94:95], exec, vcc
  s_ff1_i32_b64 s96, s[94:95]
  s_lshl_b64 s[94:95], 1, s96
  s_mov_b64 exec, s[94:95]
L_fl1_4:
  s_sleep 1
  buffer_load_dwordx2 v[4:5], v3, s[12:15], 0 offen sc1
  s_add_u32 s97, s97, 1
  s_waitcnt vmcnt(0)
  v_cmp_eq_u64 vcc, s[68:69], v[4:5]
  s_cmp_eq_u64 vcc, exec
  s_cbranch_scc1 L_fl2_5
  s_cmp_gt_u32 s97, 60000
  s_cbranch_scc0 L_fl1_4
L_fl2_5:
  s_mov_b64 exec, -1
L_fl_3:
  v_cmp_eq_u64 vcc, s[68:69], v[4:5]
  s_cmp_eq_u64 vcc, exec
  s_cbranch_scc1 L_fld_6
  s_add_u32 s97, s97, 1
  s_cmp_gt_u32 s97, 60000
  s_cbranch_scc1 L_fld_6
  s_andn2_b64 exec, exec, vcc
  buffer_load_dwordx2 v[4:5], v3, s[12:15], 0 offen sc1
  s_mov_b64 exec, -1
  s_waitcnt vmcnt(0)
  s_branch L_fl_3
L_fld_6:
  s_lshl_b32 s86, s43, 10
  buffer_load_dwordx4 v[16:19], v6, s[12:15], s86 offen sc1
  s_add_u32 s43, s43, 1
  buffer_load_dwordx4 v[20:23], v7, s[12:15], s86 offen sc1
  s_and_b32 s43, s43, 31
  s_lshl_b32 s86, s43, 10
  buffer_load_dwordx4 v[24:27], v6, s[12:15], s86 offen sc1
  s_add_u32 s43, s43, 1
  buffer_load_dwordx4 v[28:31], v7, s[12:15], s86 offen sc1
  s_and_b32 s43, s43, 31
  s_lshl_b32 s86, s43, 10
  buffer_load_dwordx4 v[32:35], v6, s[12:15], s86 offen sc1
  s_add_u32 s43, s43, 1
  buffer_load_dwordx4 v[36:39], v7, s[12:15], s86 offen sc1
  s_and_b32 s43, s43, 31
  s_lshl_b32 s86, s43, 10
  buffer_load_dwordx4 v[40:43], v6, s[12:15], s86 offen sc1
  s_add_u32 s43, s43, 1
  buffer_load_dwordx4 v[44:47], v7, s[12:15], s86 offen sc1
  s_and_b32 s43, s43, 31
  s_lshl_b32 s86, s43, 10
  buffer_load_dwordx4 v[48:51], v6, s[12:15], s86 offen sc1
  s_add_u32 s43, s43, 1
  buffer_load_dwordx4 v[52:55], v7, s[12:15], s86 offen sc1
  s_and_b32 s43, s43, 31
  s_lshl_b32 s86, s43, 10
  buffer_load_dwordx4 v[56:59], v6, s[12:15], s86 offen sc1
  s_add_u32 s43, s43, 1
  buffer_load_dwordx4 v[60:63], v7, s[12:15], s86 offen sc1
  s_and_b32 s43, s43, 31
  s_lshl_b32 s86, s43, 10
  buffer_load_dwordx4 v[64:67], v6, s[12:15], s86 offen sc1
  s_add_u32 s43, s43, 1
  buffer_load_dwordx4 v[68:71], v7, s[12:15], s86 offen sc1
  s_and_b32 s43, s43, 31
  s_lshl_b32 s86, s43, 10
  buffer_load_dwordx4 v[72:75], v6, s[12:15], s86 offen sc1
  s_add_u32 s43, s43, 1
  buffer_load_dwordx4 v[76:79], v7, s[12:15], s86 offen sc1
  s_and_b32 s43, s43, 31
  ds_read_b64_tr_b16 v[80:81], v246 offset:0
  ds_read_b64_tr_b16 v[82:83], v246 offset:1024
  ds_read_b64_tr_b16 v[84:85], v247 offset:0
  ds_read_b64_tr_b16 v[86:87], v247 offset:1024
  s_waitcnt vmcnt(14)
  s_waitcnt vmcnt(12) lgkmcnt(0)
  v_mfma_f32_32x32x16_bf16 v[96:111], v[80:83], v[16:19], 0
  ds_read_b64_tr_b16 v[88:89], v246 offset:2048
  ds_read_b64_tr_b16 v[90:91], v246 offset:3072
  v_mfma_f32_32x32x16_bf16 v[112:127], v[84:87], v[16:19], 0
  ds_read_b64_tr_b16 v[92:93], v247 offset:2048
  ds_read_b64_tr_b16 v[94:95], v247 offset:3072
  v_mfma_f32_32x32x16_bf16 v[128:143], v[80:83], v[20:23], 0
  s_mul_i32 s87, s42, 44032
  s_add_u32 m0, s74, 0
  s_add_u32 s42, s42, 1
  buffer_load_dwordx4 v240, s[16:19], s87 offen lds
  s_add_u32 m0, s74, 1024
  s_and_b32 s42, s42, 31
  buffer_load_dwordx4 v241, s[16:19], s87 offen lds
  v_mfma_f32_32x32x16_bf16 v[144:159], v[84:87], v[20:23], 0
  s_lshl_b32 s86, s43, 10
  buffer_load_dwordx4 v[16:19], v6, s[12:15], s86 offen sc1
  s_add_u32 s43, s43, 1
  buffer_load_dwordx4 v[20:23], v7, s[12:15], s86 offen sc1
  s_and_b32 s43, s43, 31
  s_waitcnt vmcnt(14) lgkmcnt(0)
  v_mfma_f32_32x32x16_bf16 v[96:111], v[88:91], v[24:27], v[96:111]
  ds_read_b64_tr_b16 v[80:81], v246 offset:4096
  ds_read_b64_tr_b16 v[82:83], v246 offset:5120
  v_mfma_f32_32x32x16_bf16 v[112:127], v[92:95], v[24:27], v[112:127]
  ds_read_b64_tr_b16 v[84:85], v247 offset:4096
  ds_read_b64_tr_b16 v[86:87], v247 offset:5120
  v_mfma_f32_32x32x16_bf16 v[128:143], v[88:91], v[28:31], v[128:143]
  s_mul_i32 s87, s42, 44032
  s_add_u32 m0, s74, 2048
  s_add_u32 s42, s42, 1
  buffer_load_dwordx4 v240, s[16:19], s87 offen lds
  s_add_u32 m0, s74, 3072
  s_and_b32 s42, s42, 31
  buffer_load_dwordx4 v241, s[16:19], s87 offen lds
  v_mfma_f32_32x32x16_bf16 v[144:159], v[92:95], v[28:31], v[144:159]
  s_lshl_b32 s86, s43, 10
  buffer_load_dwordx4 v[24:27], v6, s[12:15], s86 offen sc1
  s_add_u32 s43, s43, 1
  buffer_load_dwordx4 v[28:31], v7, s[12:15], s86 offen sc1
  s_and_b32 s43, s43, 31
  s_waitcnt vmcnt(16) lgkmcnt(0)
  v_mfma_f32_32x32x16_bf16 v[96:111], v[80:83], v[32:35], v[96:111]
  ds_read_b64_tr_b16 v[88:89], v246 offset:6144
  ds_read_b64_tr_b16 v[90:91], v246 offset:7168
  v_mfma_f32_32x32x16_bf16 v[112:127], v[84:87], v[32:35], v[112:127]
  ds_read_b64_tr_b16 v[92:93], v247 offset:6144
  ds_read_b64_tr_b16 v[94:95], v247 offset:7168
  v_mfma_f32_32x32x16_bf16 v[128:143], v[80:83], v[36:39], v[128:143]
  s_mul_i32 s87, s42, 44032
  s_add_u32 m0, s74, 4096
  s_add_u32 s42, s42, 1
  buffer_load_dwordx4 v240, s[16:19], s87 offen lds
  s_add_u32 m0, s74, 5120
  s_and_b32 s42, s42, 31
  buffer_load_dwordx4 v241, s[16:19], s87 offen lds
  v_mfma_f32_32x32x16_bf16 v[144:159], v[84:87], v[36:39], v[144:159]
  s_lshl_b32 s86, s43, 10
  buffer_load_dwordx4 v[32:35], v6, s[12:15], s86 offen sc1
  s_add_u32 s43, s43, 1
  buffer_load_dwordx4 v[36:39], v7, s[12:15], s86 offen sc1
  s_and_b32 s43, s43, 31
  s_waitcnt vmcnt(18) lgkmcnt(0)
  v_mfma_f32_32x32x16_bf16 v[96:111], v[88:91], v[40:43], v[96:111]
  ds_read_b64_tr_b16 v[80:81], v246 offset:8192
  ds_read_b64_tr_b16 v[82:83], v246 offset:9216
  v_mfma_f32_32x32x16_bf16 v[112:127], v[92:95], v[40:43], v[112:127]
  ds_read_b64_tr_b16 v[84:85], v247 offset:8192
  ds_read_b64_tr_b16 v[86:87], v247 offset:9216
  v_mfma_f32_32x32x16_bf16 v[128:143], v[88:91], v[44:47], v[128:143]
  s_mul_i32 s87, s42, 44032
  s_add_u32 m0, s74, 6144
  s_add_u32 s42, s42, 1
  buffer_load_dwordx4 v240, s[16:19], s87 offen lds
  s_add_u32 m0, s74, 7168
  s_and_b32 s42, s42, 31
  buffer_load_dwordx4 v241, s[16:19], s87 offen lds
  v_mfma_f32_32x32x16_bf16 v[144:159], v[92:95], v[44:47], v[144:159]
  s_lshl_b32 s86, s43, 10
  buffer_load_dwordx4 v[40:43], v6, s[12:15], s86 offen sc1
  s_add_u32 s43, s43, 1
  buffer_load_dwordx4 v[44:47], v7, s[12:15], s86 offen sc1
  s_and_b32 s43, s43, 31
  s_waitcnt vmcnt(14) lgkmcnt(0)
  v_mfma_f32_32x32x16_bf16 v[96:111], v[80:83], v[48:51], v[96:111]
  ds_read_b64_tr_b16 v[88:89], v246 offset:0
  ds_read_b64_tr_b16 v[90:91], v246 offset:1024
  v_mfma_f32_32x32x16_bf16 v[112:127], v[84:87], v[48:51], v[112:127]
  ds_read_b64_tr_b16 v[92:93], v247 offset:0
  ds_read_b64_tr_b16 v[94:95], v247 offset:1024
  v_mfma_f32_32x32x16_bf16 v[128:143], v[80:83], v[52:55], v[128:143]
  s_mul_i32 s87, s42, 44032
  s_add_u32 m0, s74, 8192
  s_add_u32 s42, s42, 1
  buffer_load_dwordx4 v240, s[16:19], s87 offen lds
  s_add_u32 m0, s74, 9216
  s_and_b32 s42, s42, 31
  buffer_load_dwordx4 v241, s[16:19], s87 offen lds
  v_mfma_f32_32x32x16_bf16 v[144:159], v[84:87], v[52:55], v[144:159]
  s_lshl_b32 s86, s43, 10
  buffer_load_dwordx4 v[48:51], v6, s[12:15], s86 offen sc1
  s_add_u32 s43, s43, 1
  buffer_load_dwordx4 v[52:55], v7, s[12:15], s86 offen sc1
  s_and_b32 s43, s43, 31
  s_waitcnt vmcnt(14) lgkmcnt(0)
  v_mfma_f32_32x32x16_bf16 v[96:111], v[88:91], v[56:59], v[96:111]
  ds_read_b64_tr_b16 v[80:81], v246 offset:2048
  ds_read_b64_tr_b16 v[82:83], v246 offset:3072
  v_mfma_f32_32x32x16_bf16 v[112:127], v[92:95], v[56:59], v[112:127]
  ds_read_b64_tr_b16 v[84:85], v247 offset:2048
  ds_read_b64_tr_b16 v[86:87], v247 offset:3072
  v_mfma_f32_32x32x16_bf16 v[128:143], v[88:91], v[60:63], v[128:143]
  s_mul_i32 s87, s42, 44032
  s_add_u32 m0, s74, 0
  s_add_u32 s42, s42, 1
  buffer_load_dwordx4 v240, s[16:19], s87 offen lds
  s_add_u32 m0, s74, 1024
  s_and_b32 s42, s42, 31
  buffer_load_dwordx4 v241, s[16:19], s87 offen lds
  v_mfma_f32_32x32x16_bf16 v[144:159], v[92:95], v[60:63], v[144:159]
  s_lshl_b32 s86, s43, 10
  buffer_load_dwordx4 v[56:59], v6, s[12:15], s86 offen sc1
  s_add_u32 s43, s43, 1
  buffer_load_dwordx4 v[60:63], v7, s[12:15], s86 offen sc1
  s_and_b32 s43, s43, 31
  s_waitcnt vmcnt(14) lgkmcnt(0)
  v_mfma_f32_32x32x16_bf16 v[96:111], v[80:83], v[64:67], v[96:111]
  ds_read_b64_tr_b16 v[88:89], v246 offset:4096
  ds_read_b64_tr_b16 v[90:91], v246 offset:5120
  v_mfma_f32_32x32x16_bf16 v[112:127], v[84:87], v[64:67], v[112:127]
  ds_read_b64_tr_b16 v[92:93], v247 offset:4096
  ds_read_b64_tr_b16 v[94:95], v247 offset:5120
  v_mfma_f32_32x32x16_bf16 v[128:143], v[80:83], v[68:71], v[128:143]
  s_mul_i32 s87, s42, 44032
  s_add_u32 m0, s74, 2048
  s_add_u32 s42, s42, 1
  buffer_load_dwordx4 v240, s[16:19], s87 offen lds
  s_add_u32 m0, s74, 3072
  s_and_b32 s42, s42, 31
  buffer_load_dwordx4 v241, s[16:19], s87 offen lds
  v_mfma_f32_32x32x16_bf16 v[144:159], v[84:87], v[68:71], v[144:159]
  s_lshl_b32 s86, s43, 10
  buffer_load_dwordx4 v[64:67], v6, s[12:15], s86 offen sc1
  s_add_u32 s43, s43, 1
  buffer_load_dwordx4 v[68:71], v7, s[12:15], s86 offen sc1
  s_and_b32 s43, s43, 31
  s_waitcnt vmcnt(14) lgkmcnt(0)
  v_mfma_f32_32x32x16_bf16 v[96:111], v[88:91], v[72:75], v[96:111]
  ds_read_b64_tr_b16 v[80:81], v246 offset:6144
  ds_read_b64_tr_b16 v[82:83], v246 offset:7168
  v_mfma_f32_32x32x16_bf16 v[112:127], v[92:95], v[72:75], v[112:127]
  ds_read_b64_tr_b16 v[84:85], v247 offset:6144
  ds_read_b64_tr_b16 v[86:87], v247 offset:7168
  v_mfma_f32_32x32x16_bf16 v[128:143], v[88:91], v[76:79], v[128:143]
  s_mul_i32 s87, s42, 44032
  s_add_u32 m0, s74, 4096
  s_add_u32 s42, s42, 1
  buffer_load_dwordx4 v240, s[16:19], s87 offen lds
  s_add_u32 m0, s74, 5120
  s_and_b32 s42, s42, 31
  buffer_load_dwordx4 v241, s[16:19], s87 offen lds
  v_mfma_f32_32x32x16_bf16 v[144:159], v[92:95], v[76:79], v[144:159]
  s_lshl_b32 s86, s43, 10
  buffer_load_dwordx4 v[72:75], v6, s[12:15], s86 offen sc1
  s_add_u32 s43, s43, 1
  buffer_load_dwordx4 v[76:79], v7, s[12:15], s86 offen sc1
  s_and_b32 s43, s43, 31
  s_waitcnt vmcnt(14) lgkmcnt(0)
  v_mfma_f32_32x32x16_bf16 v[96:111], v[80:83], v[16:19], v[96:111]
  ds_read_b64_tr_b16 v[88:89], v246 offset:8192
  ds_read_b64_tr_b16 v[90:91], v246 offset:9216
  v_mfma_f32_32x32x16_bf16 v[112:127], v[84:87], v[16:19], v[112:127]
  ds_read_b64_tr_b16 v[92:93], v247 offset:8192
  ds_read_b64_tr_b16 v[94:95], v247 offset:9216
  v_mfma_f32_32x32x16_bf16 v[128:143], v[80:83], v[20:23], v[128:143]
  s_mul_i32 s87, s42, 44032
  s_add_u32 m0, s74, 6144
  s_add_u32 s42, s42, 1
  buffer_load_dwordx4 v240, s[16:19], s87 offen lds
  s_add_u32 m0, s74, 7168
  s_and_b32 s42, s42, 31
  buffer_load_dwordx4 v241, s[16:19], s87 offen lds
  v_mfma_f32_32x32x16_bf16 v[144:159], v[84:87], v[20:23], v[144:159]
  s_lshl_b32 s86, s43, 10
  buffer_load_dwordx4 v[16:19], v6, s[12:15], s86 offen sc1
  s_add_u32 s43, s43, 1
  buffer_load_dwordx4 v[20:23], v7, s[12:15], s86 offen sc1
  s_and_b32 s43, s43, 31
  s_waitcnt vmcnt(14) lgkmcnt(0)
  v_mfma_f32_32x32x16_bf16 v[96:111], v[88:91], v[24:27], v[96:111]
  ds_read_b64_tr_b16 v[80:81], v246 offset:0
  ds_read_b64_tr_b16 v[82:83], v246 offset:1024
  v_mfma_f32_32x32x16_bf16 v[112:127], v[92:95], v[24:27], v[112:127]
  ds_read_b64_tr_b16 v[84:85], v247 offset:0
  ds_read_b64_tr_b16 v[86:87], v247 offset:1024
  v_mfma_f32_32x32x16_bf16 v[128:143], v[88:91], v[28:31], v[128:143]
  s_mul_i32 s87, s42, 44032
  s_add_u32 m0, s74, 8192
  s_add_u32 s42, s42, 1
  buffer_load_dwordx4 v240, s[16:19], s87 offen lds
  s_add_u32 m0, s74, 9216
  s_and_b32 s42, s42, 31
  buffer_load_dwordx4 v241, s[16:19], s87 offen lds
  v_mfma_f32_32x32x16_bf16 v[144:159], v[92:95], v[28:31], v[144:159]
  s_lshl_b32 s86, s43, 10
  buffer_load_dwordx4 v[24:27], v6, s[12:15], s86 offen sc1
  s_add_u32 s43, s43, 1
  buffer_load_dwordx4 v[28:31], v7, s[12:15], s86 offen sc1
  s_and_b32 s43, s43, 31
  s_waitcnt vmcnt(14) lgkmcnt(0)
  v_mfma_f32_32x32x16_bf16 v[96:111], v[80:83], v[32:35], v[96:111]
  ds_read_b64_tr_b16 v[88:89], v246 offset:2048
  ds_read_b64_tr_b16 v[90:91], v246 offset:3072
  v_mfma_f32_32x32x16_bf16 v[112:127], v[84:87], v[32:35], v[112:127]
  ds_read_b64_tr_b16 v[92:93], v247 offset:2048
  ds_read_b64_tr_b16 v[94:95], v247 offset:3072
  v_mfma_f32_32x32x16_bf16 v[128:143], v[80:83], v[36:39], v[128:143]
  s_mul_i32 s87, s42, 44032
  s_add_u32 m0, s74, 0
  s_add_u32 s42, s42, 1
  buffer_load_dwordx4 v240, s[16:19], s87 offen lds
  s_add_u32 m0, s74, 1024
  s_and_b32 s42, s42, 31
  buffer_load_dwordx4 v241, s[16:19], s87 offen lds
  v_mfma_f32_32x32x16_bf16 v[144:159], v[84:87], v[36:39], v[144:159]
  s_lshl_b32 s86, s43, 10
  buffer_load_dwordx4 v[32:35], v6, s[12:15], s86 offen sc1
  s_add_u32 s43, s43, 1
  buffer_load_dwordx4 v[36:39], v7, s[12:15], s86 offen sc1
  s_and_b32 s43, s43, 31
  s_waitcnt vmcnt(14) lgkmcnt(0)
  v_mfma_f32_32x32x16_bf16 v[96:111], v[88:91], v[40:43], v[96:111]
  ds_read_b64_tr_b16 v[80:81], v246 offset:4096
  ds_read_b64_tr_b16 v[82:83], v246 offset:5120
  v_mfma_f32_32x32x16_bf16 v[112:127], v[92:95], v[40:43], v[112:127]
  ds_read_b64_tr_b16 v[84:85], v247 offset:4096
  ds_read_b64_tr_b16 v[86:87], v247 offset:5120
  v_mfma_f32_32x32x16_bf16 v[128:143], v[88:91], v[44:47], v[128:143]
  s_mul_i32 s87, s42, 44032
  s_add_u32 m0, s74, 2048
  s_add_u32 s42, s42, 1
  buffer_load_dwordx4 v240, s[16:19], s87 offen lds
  s_add_u32 m0, s74, 3072
  s_and_b32 s42, s42, 31
  buffer_load_dwordx4 v241, s[16:19], s87 offen lds
  v_mfma_f32_32x32x16_bf16 v[144:159], v[92:95], v[44:47], v[144:159]
  s_lshl_b32 s86, s43, 10
  buffer_load_dwordx4 v[40:43], v6, s[12:15], s86 offen sc1
  s_add_u32 s43, s43, 1
  buffer_load_dwordx4 v[44:47], v7, s[12:15], s86 offen sc1
  s_and_b32 s43, s43, 31
  s_waitcnt vmcnt(14) lgkmcnt(0)
  v_mfma_f32_32x32x16_bf16 v[96:111], v[80:83], v[48:51], v[96:111]
  ds_read_b64_tr_b16 v[88:89], v246 offset:6144
  ds_read_b64_tr_b16 v[90:91], v246 offset:7168
  v_mfma_f32_32x32x16_bf16 v[112:127], v[84:87], v[48:51], v[112:127]
  ds_read_b64_tr_b16 v[92:93], v247 offset:6144
  ds_read_b64_tr_b16 v[94:95], v247 offset:7168
  v_mfma_f32_32x32x16_bf16 v[128:143], v[80:83], v[52:55], v[128:143]
  s_mul_i32 s87, s42, 44032
  s_add_u32 m0, s74, 4096
  s_add_u32 s42, s42, 1
  buffer_load_dwordx4 v240, s[16:19], s87 offen lds
  s_add_u32 m0, s74, 5120
  s_and_b32 s42, s42, 31
  buffer_load_dwordx4 v241, s[16:19], s87 offen lds
  v_mfma_f32_32x32x16_bf16 v[144:159], v[84:87], v[52:55], v[144:159]
  s_lshl_b32 s86, s43, 10
  buffer_load_dwordx4 v[48:51], v6, s[12:15], s86 offen sc1
  s_add_u32 s43, s43, 1
  buffer_load_dwordx4 v[52:55], v7, s[12:15], s86 offen sc1
  s_and_b32 s43, s43, 31
  s_waitcnt vmcnt(14) lgkmcnt(0)
  v_mfma_f32_32x32x16_bf16 v[96:111], v[88:91], v[56:59], v[96:111]
  ds_read_b64_tr_b16 v[80:81], v246 offset:8192
  ds_read_b64_tr_b16 v[82:83], v246 offset:9216
  v_mfma_f32_32x32x16_bf16 v[112:127], v[92:95], v[56:59], v[112:127]
  ds_read_b64_tr_b16 v[84:85], v247 offset:8192
  ds_read_b64_tr_b16 v[86:87], v247 offset:9216
  v_mfma_f32_32x32x16_bf16 v[128:143], v[88:91], v[60:63], v[128:143]
  s_mul_i32 s87, s42, 44032
  s_add_u32 m0, s74, 6144
  s_add_u32 s42, s42, 1
  buffer_load_dwordx4 v240, s[16:19], s87 offen lds
  s_add_u32 m0, s74, 7168
  s_and_b32 s42, s42, 31
  buffer_load_dwordx4 v241, s[16:19], s87 offen lds
  v_mfma_f32_32x32x16_bf16 v[144:159], v[92:95], v[60:63], v[144:159]
  s_lshl_b32 s86, s43, 10
  buffer_load_dwordx4 v[56:59], v6, s[12:15], s86 offen sc1
  s_add_u32 s43, s43, 1
  buffer_load_dwordx4 v[60:63], v7, s[12:15], s86 offen sc1
  s_and_b32 s43, s43, 31
  s_waitcnt vmcnt(14) lgkmcnt(0)
  v_mfma_f32_32x32x16_bf16 v[96:111], v[80:83], v[64:67], v[96:111]
  ds_read_b64_tr_b16 v[88:89], v246 offset:0
  ds_read_b64_tr_b16 v[90:91], v246 offset:1024
  v_mfma_f32_32x32x16_bf16 v[112:127], v[84:87], v[64:67], v[112:127]
  ds_read_b64_tr_b16 v[92:93], v247 offset:0
  ds_read_b64_tr_b16 v[94:95], v247 offset:1024
  v_mfma_f32_32x32x16_bf16 v[128:143], v[80:83], v[68:71], v[128:143]
  s_mul_i32 s87, s42, 44032
  s_add_u32 m0, s74, 8192
  s_add_u32 s42, s42, 1
  buffer_load_dwordx4 v240, s[16:19], s87 offen lds
  s_add_u32 m0, s74, 9216
  s_and_b32 s42, s42, 31
  buffer_load_dwordx4 v241, s[16:19], s87 offen lds
  v_mfma_f32_32x32x16_bf16 v[144:159], v[84:87], v[68:71], v[144:159]
  s_lshl_b32 s86, s43, 10
  buffer_load_dwordx4 v[64:67], v6, s[12:15], s86 offen sc1
  s_add_u32 s43, s43, 1
  buffer_load_dwordx4 v[68:71], v7, s[12:15], s86 offen sc1
  s_and_b32 s43, s43, 31
  s_waitcnt vmcnt(14) lgkmcnt(0)
  v_mfma_f32_32x32x16_bf16 v[96:111], v[88:91], v[72:75], v[96:111]
  ds_read_b64_tr_b16 v[80:81], v246 offset:2048
  ds_read_b64_tr_b16 v[82:83], v246 offset:3072
  v_mfma_f32_32x32x16_bf16 v[112:127], v[92:95], v[72:75], v[112:127]
  ds_read_b64_tr_b16 v[84:85], v247 offset:2048
  ds_read_b64_tr_b16 v[86:87], v247 offset:3072
  v_mfma_f32_32x32x16_bf16 v[128:143], v[88:91], v[76:79], v[128:143]
  s_mul_i32 s87, s42, 44032
  s_add_u32 m0, s74, 0
  s_add_u32 s42, s42, 1
  buffer_load_dwordx4 v240, s[16:19], s87 offen lds
  s_add_u32 m0, s74, 1024
  s_and_b32 s42, s42, 31
  buffer_load_dwordx4 v241, s[16:19], s87 offen lds
  v_mfma_f32_32x32x16_bf16 v[144:159], v[92:95], v[76:79], v[144:159]
  s_lshl_b32 s86, s43, 10
  buffer_load_dwordx4 v[72:75], v6, s[12:15], s86 offen sc1
  s_add_u32 s43, s43, 1
  buffer_load_dwordx4 v[76:79], v7, s[12:15], s86 offen sc1
  s_and_b32 s43, s43, 31
  s_waitcnt vmcnt(14) lgkmcnt(0)
  v_mfma_f32_32x32x16_bf16 v[96:111], v[80:83], v[16:19], v[96:111]
  ds_read_b64_tr_b16 v[88:89], v246 offset:4096
  ds_read_b64_tr_b16 v[90:91], v246 offset:5120
  v_mfma_f32_32x32x16_bf16 v[112:127], v[84:87], v[16:19], v[112:127]
  ds_read_b64_tr_b16 v[92:93], v247 offset:4096
  ds_read_b64_tr_b16 v[94:95], v247 offset:5120
  v_mfma_f32_32x32x16_bf16 v[128:143], v[80:83], v[20:23], v[128:143]
  s_mul_i32 s87, s42, 44032
  s_add_u32 m0, s74, 2048
  s_add_u32 s42, s42, 1
  buffer_load_dwordx4 v240, s[16:19], s87 offen lds
  s_add_u32 m0, s74, 3072
  s_and_b32 s42, s42, 31
  buffer_load_dwordx4 v241, s[16:19], s87 offen lds
  v_mfma_f32_32x32x16_bf16 v[144:159], v[84:87], v[20:23], v[144:159]
  s_lshl_b32 s86, s43, 10
  buffer_load_dwordx4 v[16:19], v6, s[12:15], s86 offen sc1
  s_add_u32 s43, s43, 1
  buffer_load_dwordx4 v[20:23], v7, s[12:15], s86 offen sc1
  s_and_b32 s43, s43, 31
  s_waitcnt vmcnt(14) lgkmcnt(0)
  v_mfma_f32_32x32x16_bf16 v[96:111], v[88:91], v[24:27], v[96:111]
  ds_read_b64_tr_b16 v[80:81], v246 offset:6144
  ds_read_b64_tr_b16 v[82:83], v246 offset:7168
  v_mfma_f32_32x32x16_bf16 v[112:127], v[92:95], v[24:27], v[112:127]
  ds_read_b64_tr_b16 v[84:85], v247 offset:6144
  ds_read_b64_tr_b16 v[86:87], v247 offset:7168
  v_mfma_f32_32x32x16_bf16 v[128:143], v[88:91], v[28:31], v[128:143]
  s_mul_i32 s87, s42, 44032
  s_add_u32 m0, s74, 4096
  s_add_u32 s42, s42, 1
  buffer_load_dwordx4 v240, s[16:19], s87 offen lds
  s_add_u32 m0, s74, 5120
  s_and_b32 s42, s42, 31
  buffer_load_dwordx4 v241, s[16:19], s87 offen lds
  v_mfma_f32_32x32x16_bf16 v[144:159], v[92:95], v[28:31], v[144:159]
  s_lshl_b32 s86, s43, 10
  buffer_load_dwordx4 v[24:27], v6, s[12:15], s86 offen sc1
  s_add_u32 s43, s43, 1
  buffer_load_dwordx4 v[28:31], v7, s[12:15], s86 offen sc1
  s_and_b32 s43, s43, 31
  s_waitcnt vmcnt(14) lgkmcnt(0)
  v_mfma_f32_32x32x16_bf16 v[96:111], v[80:83], v[32:35], v[96:111]
  ds_read_b64_tr_b16 v[88:89], v246 offset:8192
  ds_read_b64_tr_b16 v[90:91], v246 offset:9216
  v_mfma_f32_32x32x16_bf16 v[112:127], v[84:87], v[32:35], v[112:127]
  ds_read_b64_tr_b16 v[92:93], v247 offset:8192
  ds_read_b64_tr_b16 v[94:95], v247 offset:9216
  v_mfma_f32_32x32x16_bf16 v[128:143], v[80:83], v[36:39], v[128:143]
  s_mul_i32 s87, s42, 44032
  s_add_u32 m0, s74, 6144
  s_add_u32 s42, s42, 1
  buffer_load_dwordx4 v240, s[16:19], s87 offen lds
  s_add_u32 m0, s74, 7168
  s_and_b32 s42, s42, 31
  buffer_load_dwordx4 v241, s[16:19], s87 offen lds
  v_mfma_f32_32x32x16_bf16 v[144:159], v[84:87], v[36:39], v[144:159]
  s_lshl_b32 s86, s43, 10
  buffer_load_dwordx4 v[32:35], v6, s[12:15], s86 offen sc1
  s_add_u32 s43, s43, 1
  buffer_load_dwordx4 v[36:39], v7, s[12:15], s86 offen sc1
  s_and_b32 s43, s43, 31
  s_waitcnt vmcnt(14) lgkmcnt(0)
  v_mfma_f32_32x32x16_bf16 v[96:111], v[88:91], v[40:43], v[96:111]
  ds_read_b64_tr_b16 v[80:81], v246 offset:0
  ds_read_b64_tr_b16 v[82:83], v246 offset:1024
  v_mfma_f32_32x32x16_bf16 v[112:127], v[92:95], v[40:43], v[112:127]
  ds_read_b64_tr_b16 v[84:85], v247 offset:0
  ds_read_b64_tr_b16 v[86:87], v247 offset:1024
  v_mfma_f32_32x32x16_bf16 v[128:143], v[88:91], v[44:47], v[128:143]
  s_mul_i32 s87, s42, 44032
  s_add_u32 m0, s74, 8192
  s_add_u32 s42, s42, 1
  buffer_load_dwordx4 v240, s[16:19], s87 offen lds
  s_add_u32 m0, s74, 9216
  s_and_b32 s42, s42, 31
  buffer_load_dwordx4 v241, s[16:19], s87 offen lds
  v_mfma_f32_32x32x16_bf16 v[144:159], v[92:95], v[44:47], v[144:159]
  s_lshl_b32 s86, s43, 10
  buffer_load_dwordx4 v[40:43], v6, s[12:15], s86 offen sc1
  s_add_u32 s43, s43, 1
  buffer_load_dwordx4 v[44:47], v7, s[12:15], s86 offen sc1
  s_and_b32 s43, s43, 31
  s_waitcnt vmcnt(14) lgkmcnt(0)
  v_mfma_f32_32x32x16_bf16 v[96:111], v[80:83], v[48:51], v[96:111]
  ds_read_b64_tr_b16 v[88:89], v246 offset:2048
  ds_read_b64_tr_b16 v[90:91], v246 offset:3072
  v_mfma_f32_32x32x16_bf16 v[112:127], v[84:87], v[48:51], v[112:127]
  ds_read_b64_tr_b16 v[92:93], v247 offset:2048
  ds_read_b64_tr_b16 v[94:95], v247 offset:3072
  v_mfma_f32_32x32x16_bf16 v[128:143], v[80:83], v[52:55], v[128:143]
  s_mul_i32 s87, s42, 44032
  s_add_u32 m0, s74, 0
  s_add_u32 s42, s42, 1
  buffer_load_dwordx4 v240, s[16:19], s87 offen lds
  s_add_u32 m0, s74, 1024
  s_and_b32 s42, s42, 31
  buffer_load_dwordx4 v241, s[16:19], s87 offen lds
  v_mfma_f32_32x32x16_bf16 v[144:159], v[84:87], v[52:55], v[144:159]
  s_lshl_b32 s86, s43, 10
  buffer_load_dwordx4 v[48:51], v6, s[12:15], s86 offen sc1
  s_add_u32 s43, s43, 1
  buffer_load_dwordx4 v[52:55], v7, s[12:15], s86 offen sc1
  s_and_b32 s43, s43, 31
  s_waitcnt vmcnt(14) lgkmcnt(0)
  v_mfma_f32_32x32x16_bf16 v[96:111], v[88:91], v[56:59], v[96:111]
  ds_read_b64_tr_b16 v[80:81], v246 offset:4096
  ds_read_b64_tr_b16 v[82:83], v246 offset:5120
  v_mfma_f32_32x32x16_bf16 v[112:127], v[92:95], v[56:59], v[112:127]
  ds_read_b64_tr_b16 v[84:85], v247 offset:4096
  ds_read_b64_tr_b16 v[86:87], v247 offset:5120
  v_mfma_f32_32x32x16_bf16 v[128:143], v[88:91], v[60:63], v[128:143]
  s_mul_i32 s87, s42, 44032
  s_add_u32 m0, s74, 2048
  s_add_u32 s42, s42, 1
  buffer_load_dwordx4 v240, s[16:19], s87 offen lds
  s_add_u32 m0, s74, 3072
  s_and_b32 s42, s42, 31
  buffer_load_dwordx4 v241, s[16:19], s87 offen lds
  v_mfma_f32_32x32x16_bf16 v[144:159], v[92:95], v[60:63], v[144:159]
  s_lshl_b32 s86, s43, 10
  buffer_load_dwordx4 v[56:59], v6, s[12:15], s86 offen sc1
  s_add_u32 s43, s43, 1
  buffer_load_dwordx4 v[60:63], v7, s[12:15], s86 offen sc1
  s_and_b32 s43, s43, 31
  s_waitcnt vmcnt(14) lgkmcnt(0)
  v_mfma_f32_32x32x16_bf16 v[96:111], v[80:83], v[64:67], v[96:111]
  ds_read_b64_tr_b16 v[88:89], v246 offset:6144
  ds_read_b64_tr_b16 v[90:91], v246 offset:7168
  v_mfma_f32_32x32x16_bf16 v[112:127], v[84:87], v[64:67], v[112:127]
  ds_read_b64_tr_b16 v[92:93], v247 offset:6144
  ds_read_b64_tr_b16 v[94:95], v247 offset:7168
  v_mfma_f32_32x32x16_bf16 v[128:143], v[80:83], v[68:71], v[128:143]
  s_mul_i32 s87, s42, 44032
  s_add_u32 m0, s74, 4096
  s_add_u32 s42, s42, 1
  buffer_load_dwordx4 v240, s[16:19], s87 offen lds
  s_add_u32 m0, s74, 5120
  s_and_b32 s42, s42, 31
  buffer_load_dwordx4 v241, s[16:19], s87 offen lds
  v_mfma_f32_32x32x16_bf16 v[144:159], v[84:87], v[68:71], v[144:159]
  s_lshl_b32 s86, s43, 10
  buffer_load_dwordx4 v[64:67], v6, s[12:15], s86 offen sc1
  s_add_u32 s43, s43, 1
  buffer_load_dwordx4 v[68:71], v7, s[12:15], s86 offen sc1
  s_and_b32 s43, s43, 31
  s_waitcnt vmcnt(14) lgkmcnt(0)
  v_mfma_f32_32x32x16_bf16 v[96:111], v[88:91], v[72:75], v[96:111]
  ds_read_b64_tr_b16 v[80:81], v246 offset:8192
  ds_read_b64_tr_b16 v[82:83], v246 offset:9216
  v_mfma_f32_32x32x16_bf16 v[112:127], v[92:95], v[72:75], v[112:127]
  ds_read_b64_tr_b16 v[84:85], v247 offset:8192
  ds_read_b64_tr_b16 v[86:87], v247 offset:9216
  v_mfma_f32_32x32x16_bf16 v[128:143], v[88:91], v[76:79], v[128:143]
  s_mul_i32 s87, s42, 44032
  s_add_u32 m0, s74, 6144
  s_add_u32 s42, s42, 1
  buffer_load_dwordx4 v240, s[16:19], s87 offen lds
  s_add_u32 m0, s74, 7168
  s_and_b32 s42, s42, 31
  buffer_load_dwordx4 v241, s[16:19], s87 offen lds
  v_mfma_f32_32x32x16_bf16 v[144:159], v[92:95], v[76:79], v[144:159]
  s_lshl_b32 s86, s43, 10
  buffer_load_dwordx4 v[72:75], v6, s[12:15], s86 offen sc1
  s_add_u32 s43, s43, 1
  buffer_load_dwordx4 v[76:79], v7, s[12:15], s86 offen sc1
  s_and_b32 s43, s43, 31
  s_waitcnt vmcnt(14) lgkmcnt(0)
  v_mfma_f32_32x32x16_bf16 v[96:111], v[80:83], v[16:19], v[96:111]
  ds_read_b64_tr_b16 v[88:89], v246 offset:0
  ds_read_b64_tr_b16 v[90:91], v246 offset:1024
  v_mfma_f32_32x32x16_bf16 v[112:127], v[84:87], v[16:19], v[112:127]
  ds_read_b64_tr_b16 v[92:93], v247 offset:0
  ds_read_b64_tr_b16 v[94:95], v247 offset:1024
  v_mfma_f32_32x32x16_bf16 v[128:143], v[80:83], v[20:23], v[128:143]
  s_mul_i32 s87, s42, 44032
  s_add_u32 m0, s74, 8192
  s_add_u32 s42, s42, 1
  buffer_load_dwordx4 v240, s[16:19], s87 offen lds
  s_add_u32 m0, s74, 9216
  s_and_b32 s42, s42, 31
  buffer_load_dwordx4 v241, s[16:19], s87 offen lds
  v_mfma_f32_32x32x16_bf16 v[144:159], v[84:87], v[20:23], v[144:159]
  s_waitcnt vmcnt(12) lgkmcnt(0)
  v_mfma_f32_32x32x16_bf16 v[96:111], v[88:91], v[24:27], v[96:111]
  ds_read_b64_tr_b16 v[80:81], v246 offset:2048
  ds_read_b64_tr_b16 v[82:83], v246 offset:3072
  v_mfma_f32_32x32x16_bf16 v[112:127], v[92:95], v[24:27], v[112:127]
  ds_read_b64_tr_b16 v[84:85], v247 offset:2048
  ds_read_b64_tr_b16 v[86:87], v247 offset:3072
  v_mfma_f32_32x32x16_bf16 v[128:143], v[88:91], v[28:31], v[128:143]
  s_mul_i32 s87, s42, 44032
  s_add_u32 m0, s74, 0
  s_add_u32 s42, s42, 1
  buffer_load_dwordx4 v240, s[16:19], s87 offen lds
  s_add_u32 m0, s74, 1024
  s_and_b32 s42, s42, 31
  buffer_load_dwordx4 v241, s[16:19], s87 offen lds
  v_mfma_f32_32x32x16_bf16 v[144:159], v[92:95], v[28:31], v[144:159]
  s_waitcnt vmcnt(10) lgkmcnt(0)
  s_mov_b32 s97, 0
L_lw_7:
  ds_read_b32 v11, v251 offset:20
  s_waitcnt lgkmcnt(0)
  v_readfirstlane_b32 s96, v11
  s_add_u32 s97, s97, 1
  s_cmp_ge_u32 s96, 4
  s_cbranch_scc1 L_lwd_8
  s_cmp_gt_u32 s97, 240000
  s_cbranch_scc1 L_lwd_8
  s_branch L_lw_7
L_lwd_8:
  v_mfma_f32_32x32x16_bf16 v[96:111], v[80:83], v[32:35], v[96:111]
  ds_read_b64_tr_b16 v[88:89], v246 offset:4096
  ds_read_b64_tr_b16 v[90:91], v246 offset:5120
  v_mfma_f32_32x32x16_bf16 v[112:127], v[84:87], v[32:35], v[112:127]
  ds_read_b64_tr_b16 v[92:93], v247 offset:4096
  ds_read_b64_tr_b16 v[94:95], v247 offset:5120
  v_mfma_f32_32x32x16_bf16 v[128:143], v[80:83], v[36:39], v[128:143]
  s_mul_i32 s87, s42, 44032
  s_add_u32 m0, s74, 2048
  s_add_u32 s42, s42, 1
  buffer_load_dwordx4 v240, s[16:19], s87 offen lds
  s_add_u32 m0, s74, 3072
  s_and_b32 s42, s42, 31
  buffer_load_dwordx4 v241, s[16:19], s87 offen lds
  v_mfma_f32_32x32x16_bf16 v[144:159], v[84:87], v[36:39], v[144:159]
  s_waitcnt vmcnt(8) lgkmcnt(0)
  v_mfma_f32_32x32x16_bf16 v[96:111], v[88:91], v[40:43], v[96:111]
  ds_read_b64_tr_b16 v[80:81], v246 offset:6144
  ds_read_b64_tr_b16 v[82:83], v246 offset:7168
  v_mfma_f32_32x32x16_bf16 v[112:127], v[92:95], v[40:43], v[112:127]
  ds_read_b64_tr_b16 v[84:85], v247 offset:6144
  ds_read_b64_tr_b16 v[86:87], v247 offset:7168
  v_mfma_f32_32x32x16_bf16 v[128:143], v[88:91], v[44:47], v[128:143]
  s_lshl_b32 s87, s46, 16
  s_add_u32 m0, s76, 0
  s_add_u32 s46, s46, 1
  buffer_load_dwordx4 v242, s[20:23], s87 offen lds
  s_add_u32 m0, s76, 1024
  s_cmp_eq_u32 s46, 22
  s_cselect_b32 s46, 0, s46
  buffer_load_dwordx4 v243, s[20:23], s87 offen lds
  v_mfma_f32_32x32x16_bf16 v[144:159], v[92:95], v[44:47], v[144:159]
  s_waitcnt vmcnt(6) lgkmcnt(0)
  v_mov_b32 v10, 1
  s_mov_b64 exec, 1
  ds_add_u32 v251, v10 offset:36
  s_mov_b64 exec, -1
  v_mfma_f32_32x32x16_bf16 v[96:111], v[80:83], v[48:51], v[96:111]
  ds_read_b64_tr_b16 v[88:89], v246 offset:8192
  ds_read_b64_tr_b16 v[90:91], v246 offset:9216
  v_mfma_f32_32x32x16_bf16 v[112:127], v[84:87], v[48:51], v[112:127]
  ds_read_b64_tr_b16 v[92:93], v247 offset:8192
  ds_read_b64_tr_b16 v[94:95], v247 offset:9216
  v_mfma_f32_32x32x16_bf16 v[128:143], v[80:83], v[52:55], v[128:143]
  s_lshl_b32 s87, s46, 16
  s_add_u32 m0, s76, 2048
  s_add_u32 s46, s46, 1
  buffer_load_dwordx4 v242, s[20:23], s87 offen lds
  s_add_u32 m0, s76, 3072
  s_cmp_eq_u32 s46, 22
  s_cselect_b32 s46, 0, s46
  buffer_load_dwordx4 v243, s[20:23], s87 offen lds
  v_mfma_f32_32x32x16_bf16 v[144:159], v[84:87], v[52:55], v[144:159]
  s_waitcnt vmcnt(6) lgkmcnt(0)
  v_mfma_f32_32x32x16_bf16 v[96:111], v[88:91], v[56:59], v[96:111]
  ds_read_b64_tr_b16 v[80:81], v246 offset:0
  ds_read_b64_tr_b16 v[82:83], v246 offset:1024
  v_mfma_f32_32x32x16_bf16 v[112:127], v[92:95], v[56:59], v[112:127]
  ds_read_b64_tr_b16 v[84:85], v247 offset:0
  ds_read_b64_tr_b16 v[86:87], v247 offset:1024
  v_mfma_f32_32x32x16_bf16 v[128:143], v[88:91], v[60:63], v[128:143]
  s_lshl_b32 s87, s46, 16
  s_add_u32 m0, s76, 4096
  s_add_u32 s46, s46, 1
  buffer_load_dwordx4 v242, s[20:23], s87 offen lds
  s_add_u32 m0, s76, 5120
  s_cmp_eq_u32 s46, 22
  s_cselect_b32 s46, 0, s46
  buffer_load_dwordx4 v243, s[20:23], s87 offen lds
  v_mfma_f32_32x32x16_bf16 v[144:159], v[92:95], v[60:63], v[144:159]
  s_waitcnt vmcnt(6) lgkmcnt(0)
  v_mfma_f32_32x32x16_bf16 v[96:111], v[80:83], v[64:67], v[96:111]
  ds_read_b64_tr_b16 v[88:89], v246 offset:2048
  ds_read_b64_tr_b16 v[90:91], v246 offset:3072
  v_mfma_f32_32x32x16_bf16 v[112:127], v[84:87], v[64:67], v[112:127]
  ds_read_b64_tr_b16 v[92:93], v247 offset:2048
  ds_read_b64_tr_b16 v[94:95], v247 offset:3072
  v_mfma_f32_32x32x16_bf16 v[128:143], v[80:83], v[68:71], v[128:143]
  s_lshl_b32 s87, s46, 16
  s_add_u32 m0, s76, 6144
  s_add_u32 s46, s46, 1
  buffer_load_dwordx4 v242, s[20:23], s87 offen lds
  s_add_u32 m0, s76, 7168
  s_cmp_eq_u32 s46, 22
  s_cselect_b32 s46, 0, s46
  buffer_load_dwordx4 v243, s[20:23], s87 offen lds
  v_mfma_f32_32x32x16_bf16 v[144:159], v[84:87], v[68:71], v[144:159]
  s_waitcnt lgkmcnt(0)
  v_mfma_f32_32x32x16_bf16 v[96:111], v[88:91], v[72:75], v[96:111]
  v_mfma_f32_32x32x16_bf16 v[112:127], v[92:95], v[72:75], v[112:127]
  v_mfma_f32_32x32x16_bf16 v[128:143], v[88:91], v[76:79], v[128:143]
  v_mfma_f32_32x32x16_bf16 v[144:159], v[92:95], v[76:79], v[144:159]
  v_add_u32 v8, s77, v250
  s_lshl_b32 s83, s3, 12
  s_add_u32 s83, s83, 40960
  v_add_u32 v9, s83, v250
  s_nop 7
  s_nop 7
  ds_write_b128 v8, v[96:99] offset:0
  ds_write_b128 v8, v[100:103] offset:1024
  ds_write_b128 v8, v[104:107] offset:2048
  ds_write_b128 v8, v[108:111] offset:3072
  ds_write_b128 v8, v[112:115] offset:4096
  ds_write_b128 v8, v[116:119] offset:5120
  ds_write_b128 v8, v[120:123] offset:6144
  ds_write_b128 v8, v[124:127] offset:7168
  ds_write_b128 v8, v[128:131] offset:8192
  ds_write_b128 v8, v[132:135] offset:9216
  ds_write_b128 v8, v[136:139] offset:10240
  ds_write_b128 v8, v[140:143] offset:11264
  ds_write_b128 v8, v[144:147] offset:12288
  ds_write_b128 v8, v[148:151] offset:13312
  ds_write_b128 v8, v[152:155] offset:14336
  ds_write_b128 v8, v[156:159] offset:15360
  s_waitcnt lgkmcnt(0)
  v_mov_b32 v10, 1
  s_mov_b64 exec, 1
  ds_add_u32 v251, v10 offset:0
  s_mov_b64 exec, -1
  s_mov_b32 s97, 0
L_lb_9:
  ds_read_b32 v11, v251 offset:0
  s_waitcnt lgkmcnt(0)
  v_readfirstlane_b32 s96, v11
  s_add_u32 s97, s97, 1
  s_cmp_ge_u32 s96, 4
  s_cbranch_scc1 L_lbd_10
  s_cmp_gt_u32 s97, 240000
  s_cbranch_scc1 L_lbd_10
  s_branch L_lb_9
L_lbd_10:
  ds_read_b128 v[16:19], v9 offset:0
  ds_read_b128 v[20:23], v9 offset:1024
  ds_read_b128 v[24:27], v9 offset:2048
  ds_read_b128 v[28:31], v9 offset:3072
  ds_read_b128 v[32:35], v9 offset:16384
  ds_read_b128 v[36:39], v9 offset:17408
  ds_read_b128 v[40:43], v9 offset:18432
  ds_read_b128 v[44:47], v9 offset:19456
  ds_read_b128 v[48:51], v9 offset:32768
  ds_read_b128 v[52:55], v9 offset:33792
  ds_read_b128 v[56:59], v9 offset:34816
  ds_read_b128 v[60:63], v9 offset:35840
  ds_read_b128 v[64:67], v9 offset:49152
  ds_read_b128 v[68:71], v9 offset:50176
  ds_read_b128 v[72:75], v9 offset:51200
  ds_read_b128 v[76:79], v9 offset:52224
  v_lshlrev_b32 v96, 16, v224
  v_and_b32 v97, 0xffff0000, v224
  v_lshlrev_b32 v98, 16, v225
  v_and_b32 v99, 0xffff0000, v225
  v_lshlrev_b32 v100, 16, v226
  v_and_b32 v101, 0xffff0000, v226
  v_lshlrev_b32 v102, 16, v227
  v_and_b32 v103, 0xffff0000, v227
  v_lshlrev_b32 v104, 16, v228
  v_and_b32 v105, 0xffff0000, v228
  v_lshlrev_b32 v106, 16, v229
  v_and_b32 v107, 0xffff0000, v229
  v_lshlrev_b32 v108, 16, v230
  v_and_b32 v109, 0xffff0000, v230
  v_lshlrev_b32 v110, 16, v231
  v_and_b32 v111, 0xffff0000, v231
  s_waitcnt lgkmcnt(0)
  v_mov_b32 v10, 1
  s_mov_b64 exec, 1
  ds_add_u32 v251, v10 offset:12
  s_mov_b64 exec, -1
  v_add_f32 v16, v16, v32
  v_add_f32 v48, v48, v64
  v_add_f32 v96, v96, v16
  v_add_f32 v96, v96, v48
  v_add_f32 v17, v17, v33
  v_add_f32 v49, v49, v65
  v_add_f32 v97, v97, v17
  v_add_f32 v97, v97, v49
  v_add_f32 v18, v18, v34
  v_add_f32 v50, v50, v66
  v_add_f32 v98, v98, v18
  v_add_f32 v98, v98, v50
  v_add_f32 v19, v19, v35
  v_add_f32 v51, v51, v67
  v_add_f32 v99, v99, v19
  v_add_f32 v99, v99, v51
  v_add_f32 v20, v20, v36
  v_add_f32 v52, v52, v68
  v_add_f32 v100, v100, v20
  v_add_f32 v100, v100, v52
  v_add_f32 v21, v21, v37
  v_add_f32 v53, v53, v69
  v_add_f32 v101, v101, v21
  v_add_f32 v101, v101, v53
  v_add_f32 v22, v22, v38
  v_add_f32 v54, v54, v70
  v_add_f32 v102, v102, v22
  v_add_f32 v102, v102, v54
  v_add_f32 v23, v23, v39
  v_add_f32 v55, v55, v71
  v_add_f32 v103, v103, v23
  v_add_f32 v103, v103, v55
  v_add_f32 v24, v24, v40
  v_add_f32 v56, v56, v72
  v_add_f32 v104, v104, v24
  v_add_f32 v104, v104, v56
  v_add_f32 v25, v25, v41
  v_add_f32 v57, v57, v73
  v_add_f32 v105, v105, v25
  v_add_f32 v105, v105, v57
  v_add_f32 v26, v26, v42
  v_add_f32 v58, v58, v74
  v_add_f32 v106, v106, v26
  v_add_f32 v106, v106, v58
  v_add_f32 v27, v27, v43
  v_add_f32 v59, v59, v75
  v_add_f32 v107, v107, v27
  v_add_f32 v107, v107, v59
  v_add_f32 v28, v28, v44
  v_add_f32 v60, v60, v76
  v_add_f32 v108, v108, v28
  v_add_f32 v108, v108, v60
  v_add_f32 v29, v29, v45
  v_add_f32 v61, v61, v77
  v_add_f32 v109, v109, v29
  v_add_f32 v109, v109, v61
  v_add_f32 v30, v30, v46
  v_add_f32 v62, v62, v78
  v_add_f32 v110, v110, v30
  v_add_f32 v110, v110, v62
  v_add_f32 v31, v31, v47
  v_add_f32 v63, v63, v79
  v_add_f32 v111, v111, v31
  v_add_f32 v111, v111, v63
  s_mov_b32 s83, 0xbdd2d3e8
  v_mov_b32 v10, 0xc0135761
  v_mul_f32 v16, v96, v96
  v_mul_f32 v17, v97, v97
  v_mul_f32 v18, v98, v98
  v_mul_f32 v19, v99, v99
  v_mul_f32 v20, v100, v100
  v_mul_f32 v21, v101, v101
  v_mul_f32 v22, v102, v102
  v_mul_f32 v23, v103, v103
  v_mul_f32 v24, v104, v104
  v_mul_f32 v25, v105, v105
  v_mul_f32 v26, v106, v106
  v_mul_f32 v27, v107, v107
  v_mul_f32 v28, v108, v108
  v_mul_f32 v29, v109, v109
  v_mul_f32 v30, v110, v110
  v_mul_f32 v31, v111, v111
  v_fma_f32 v16, v16, s83, v10
  v_fma_f32 v17, v17, s83, v10
  v_fma_f32 v18, v18, s83, v10
  v_fma_f32 v19, v19, s83, v10
  v_fma_f32 v20, v20, s83, v10
  v_fma_f32 v21, v21, s83, v10
  v_fma_f32 v22, v22, s83, v10
  v_fma_f32 v23, v23, s83, v10
  v_fma_f32 v24, v24, s83, v10
  v_fma_f32 v25, v25, s83, v10
  v_fma_f32 v26, v26, s83, v10
  v_fma_f32 v27, v27, s83, v10
  v_fma_f32 v28, v28, s83, v10
  v_fma_f32 v29, v29, s83, v10
  v_fma_f32 v30, v30, s83, v10
  v_fma_f32 v31, v31, s83, v10
  v_mul_f32 v16, v16, v96
  v_mul_f32 v17, v17, v97
  v_mul_f32 v18, v18, v98
  v_mul_f32 v19, v19, v99
  v_mul_f32 v20, v20, v100
  v_mul_f32 v21, v21, v101
  v_mul_f32 v22, v22, v102
  v_mul_f32 v23, v23, v103
  v_mul_f32 v24, v24, v104
  v_mul_f32 v25, v25, v105
  v_mul_f32 v26, v26, v106
  v_mul_f32 v27, v27, v107
  v_mul_f32 v28, v28, v108
  v_mul_f32 v29, v29, v109
  v_mul_f32 v30, v30, v110
  v_mul_f32 v31, v31, v111
  v_exp_f32 v16, v16
  v_exp_f32 v17, v17
  v_exp_f32 v18, v18
  v_exp_f32 v19, v19
  v_exp_f32 v20, v20
  v_exp_f32 v21, v21
  v_exp_f32 v22, v22
  v_exp_f32 v23, v23
  v_exp_f32 v24, v24
  v_exp_f32 v25, v25
  v_exp_f32 v26, v26
  v_exp_f32 v27, v27
  v_exp_f32 v28, v28
  v_exp_f32 v29, v29
  v_exp_f32 v30, v30
  v_exp_f32 v31, v31
  v_add_f32 v16, 1.0, v16
  v_add_f32 v17, 1.0, v17
  v_add_f32 v18, 1.0, v18
  v_add_f32 v19, 1.0, v19
  v_add_f32 v20, 1.0, v20
  v_add_f32 v21, 1.0, v21
  v_add_f32 v22, 1.0, v22
  v_add_f32 v23, 1.0, v23
  v_add_f32 v24, 1.0, v24
  v_add_f32 v25, 1.0, v25
  v_add_f32 v26, 1.0, v26
  v_add_f32 v27, 1.0, v27
  v_add_f32 v28, 1.0, v28
  v_add_f32 v29, 1.0, v29
  v_add_f32 v30, 1.0, v30
  v_add_f32 v31, 1.0, v31
  v_rcp_f32 v16, v16
  v_rcp_f32 v17, v17
  v_rcp_f32 v18, v18
  v_rcp_f32 v19, v19
  v_rcp_f32 v20, v20
  v_rcp_f32 v21, v21
  v_rcp_f32 v22, v22
  v_rcp_f32 v23, v23
  v_rcp_f32 v24, v24
  v_rcp_f32 v25, v25
  v_rcp_f32 v26, v26
  v_rcp_f32 v27, v27
  v_rcp_f32 v28, v28
  v_rcp_f32 v29, v29
  v_rcp_f32 v30, v30
  v_rcp_f32 v31, v31
  v_mul_f32 v16, v16, v96
  v_mul_f32 v17, v17, v97
  v_mul_f32 v18, v18, v98
  v_mul_f32 v19, v19, v99
  v_mul_f32 v20, v20, v100
  v_mul_f32 v21, v21, v101
  v_mul_f32 v22, v22, v102
  v_mul_f32 v23, v23, v103
  v_mul_f32 v24, v24, v104
  v_mul_f32 v25, v25, v105
  v_mul_f32 v26, v26, v106
  v_mul_f32 v27, v27, v107
  v_mul_f32 v28, v28, v108
  v_mul_f32 v29, v29, v109
  v_mul_f32 v30, v30, v110
  v_mul_f32 v31, v31, v111
  v_cvt_pk_bf16_f32 v32, v16, v17
  v_cvt_pk_bf16_f32 v33, v18, v19
  v_cvt_pk_bf16_f32 v34, v20, v21
  v_cvt_pk_bf16_f32 v35, v22, v23
  v_cvt_pk_bf16_f32 v36, v24, v25
  v_cvt_pk_bf16_f32 v37, v26, v27
  v_cvt_pk_bf16_f32 v38, v28, v29
  v_cvt_pk_bf16_f32 v39, v30, v31
  s_lshl_b32 s83, s70, 1
  s_and_b32 s84, s3, 1
  s_add_u32 s83, s83, s84
  s_lshl_b32 s84, s71, 1
  s_lshr_b32 s85, s3, 1
  s_add_u32 s84, s84, s85
  s_lshl_b32 s85, s83, 15
  s_lshl_b32 s86, s84, 10
  s_add_u32 s85, s85, s86
  v_add_u32 v8, s85, v250
  s_movk_i32 s86, 0x4000
  buffer_store_dwordx4 v[32:35], v8, s[28:31], 0 offen sc1
  buffer_store_dwordx4 v[36:39], v8, s[28:31], s86 offen sc1
  s_lshl_b32 s83, s83, 4
  s_add_u32 s83, s83, s84
  s_lshl_b32 s83, s83, 6
  s_add_u32 s91, s83, 0xd10000
  s_mov_b32 s97, 0
L_lw_11:
  ds_read_b32 v11, v251 offset:12
  s_waitcnt lgkmcnt(0)
  v_readfirstlane_b32 s96, v11
  s_add_u32 s97, s97, 1
  s_cmp_ge_u32 s96, 4
  s_cbranch_scc1 L_lwd_12
  s_cmp_gt_u32 s97, 240000
  s_cbranch_scc1 L_lwd_12
  s_branch L_lw_11
L_lwd_12:
  s_lshl_b32 s87, s46, 16
  s_add_u32 m0, s77, 0
  s_add_u32 s46, s46, 1
  buffer_load_dwordx4 v242, s[20:23], s87 offen lds
  s_add_u32 m0, s77, 1024
  s_cmp_eq_u32 s46, 22
  s_cselect_b32 s46, 0, s46
  buffer_load_dwordx4 v243, s[20:23], s87 offen lds
  s_lshl_b32 s87, s46, 16
  s_add_u32 m0, s77, 2048
  s_add_u32 s46, s46, 1
  buffer_load_dwordx4 v242, s[20:23], s87 offen lds
  s_add_u32 m0, s77, 3072
  s_cmp_eq_u32 s46, 22
  s_cselect_b32 s46, 0, s46
  buffer_load_dwordx4 v243, s[20:23], s87 offen lds
  s_lshl_b32 s87, s46, 16
  s_add_u32 m0, s77, 4096
  s_add_u32 s46, s46, 1
  buffer_load_dwordx4 v242, s[20:23], s87 offen lds
  s_add_u32 m0, s77, 5120
  s_cmp_eq_u32 s46, 22
  s_cselect_b32 s46, 0, s46
  buffer_load_dwordx4 v243, s[20:23], s87 offen lds
  v_mov_b32 v10, s68
  v_mov_b32 v11, s69
  s_waitcnt vmcnt(6)
  s_mov_b64 exec, 1
  buffer_store_dwordx2 v[10:11], v252, s[12:15], s91 offen sc1
  s_mov_b64 exec, -1
  s_branch L_ystart
L_ln:
  s_mov_b32 s36, s56
  s_and_b32 s37, s57, 0xffff
  s_mov_b32 s38, 0x400
  s_mov_b32 s39, 0x00020000
  s_sub_u32 s90, s2, 192
  v_lshrrev_b32 v3, 3, v2
  v_and_b32 v4, 7, v2
  s_lshl_b32 s83, s90, 5
  s_lshl_b32 s84, s3, 3
  s_add_u32 s83, s83, s84
  v_add_u32 v5, s83, v3
  v_lshlrev_b32 v6, 4, v4
  v_lshl_add_u32 v7, v5, 10, v6
  s_waitcnt vmcnt(1)
  v_lshlrev_b32 v80, 16, v16
  v_and_b32 v81, 0xffff0000, v16
  v_lshlrev_b32 v82, 16, v17
  v_and_b32 v83, 0xffff0000, v17
  v_lshlrev_b32 v84, 16, v18
  v_and_b32 v85, 0xffff0000, v18
  v_lshlrev_b32 v86, 16, v19
  v_and_b32 v87, 0xffff0000, v19
  v_lshlrev_b32 v88, 16, v20
  v_and_b32 v89, 0xffff0000, v20
  v_lshlrev_b32 v90, 16, v21
  v_and_b32 v91, 0xffff0000, v21
  v_lshlrev_b32 v92, 16, v22
  v_and_b32 v93, 0xffff0000, v22
  v_lshlrev_b32 v94, 16, v23
  v_and_b32 v95, 0xffff0000, v23
  v_lshlrev_b32 v96, 16, v24
  v_and_b32 v97, 0xffff0000, v24
  v_lshlrev_b32 v98, 16, v25
  v_and_b32 v99, 0xffff0000, v25
  v_lshlrev_b32 v100, 16, v26
  v_and_b32 v101, 0xffff0000, v26
  v_lshlrev_b32 v102, 16, v27
  v_and_b32 v103, 0xffff0000, v27
  v_lshlrev_b32 v104, 16, v28
  v_and_b32 v105, 0xffff0000, v28
  v_lshlrev_b32 v106, 16, v29
  v_and_b32 v107, 0xffff0000, v29
  v_lshlrev_b32 v108, 16, v30
  v_and_b32 v109, 0xffff0000, v30
  v_lshlrev_b32 v110, 16, v31
  v_and_b32 v111, 0xffff0000, v31
  v_lshlrev_b32 v112, 16, v32
  v_and_b32 v113, 0xffff0000, v32
  v_lshlrev_b32 v114, 16, v33
  v_and_b32 v115, 0xffff0000, v33
  v_lshlrev_b32 v116, 16, v34
  v_and_b32 v117, 0xffff0000, v34
  v_lshlrev_b32 v118, 16, v35
  v_and_b32 v119, 0xffff0000, v35
  v_lshlrev_b32 v120, 16, v36
  v_and_b32 v121, 0xffff0000, v36
  v_lshlrev_b32 v122, 16, v37
  v_and_b32 v123, 0xffff0000, v37
  v_lshlrev_b32 v124, 16, v38
  v_and_b32 v125, 0xffff0000, v38
  v_lshlrev_b32 v126, 16, v39
  v_and_b32 v127, 0xffff0000, v39
  v_lshlrev_b32 v128, 16, v40
  v_and_b32 v129, 0xffff0000, v40
  v_lshlrev_b32 v130, 16, v41
  v_and_b32 v131, 0xffff0000, v41
  v_lshlrev_b32 v132, 16, v42
  v_and_b32 v133, 0xffff0000, v42
  v_lshlrev_b32 v134, 16, v43
  v_and_b32 v135, 0xffff0000, v43
  v_lshlrev_b32 v136, 16, v44
  v_and_b32 v137, 0xffff0000, v44
  v_lshlrev_b32 v138, 16, v45
  v_and_b32 v139, 0xffff0000, v45
  v_lshlrev_b32 v140, 16, v46
  v_and_b32 v141, 0xffff0000, v46
  v_lshlrev_b32 v142, 16, v47
  v_and_b32 v143, 0xffff0000, v47
  v_add_f32 v9, v80, v84
  v_add_f32 v10, v81, v85
  v_add_f32 v11, v82, v86
  v_add_f32 v12, v83, v87
  v_add_f32 v9, v9, v88
  v_add_f32 v10, v10, v89
  v_add_f32 v11, v11, v90
  v_add_f32 v12, v12, v91
  v_add_f32 v9, v9, v92
  v_add_f32 v10, v10, v93
  v_add_f32 v11, v11, v94
  v_add_f32 v12, v12, v95
  v_add_f32 v9, v9, v96
  v_add_f32 v10, v10, v97
  v_add_f32 v11, v11, v98
  v_add_f32 v12, v12, v99
  v_add_f32 v9, v9, v100
  v_add_f32 v10, v10, v101
  v_add_f32 v11, v11, v102
  v_add_f32 v12, v12, v103
  v_add_f32 v9, v9, v104
  v_add_f32 v10, v10, v105
  v_add_f32 v11, v11, v106
  v_add_f32 v12, v12, v107
  v_add_f32 v9, v9, v108
  v_add_f32 v10, v10, v109
  v_add_f32 v11, v11, v110
  v_add_f32 v12, v12, v111
  v_add_f32 v9, v9, v112
  v_add_f32 v10, v10, v113
  v_add_f32 v11, v11, v114
  v_add_f32 v12, v12, v115
  v_add_f32 v9, v9, v116
  v_add_f32 v10, v10, v117
  v_add_f32 v11, v11, v118
  v_add_f32 v12, v12, v119
  v_add_f32 v9, v9, v120
  v_add_f32 v10, v10, v121
  v_add_f32 v11, v11, v122
  v_add_f32 v12, v12, v123
  v_add_f32 v9, v9, v124
  v_add_f32 v10, v10, v125
  v_add_f32 v11, v11, v126
  v_add_f32 v12, v12, v127
  v_add_f32 v9, v9, v128
  v_add_f32 v10, v10, v129
  v_add_f32 v11, v11, v130
  v_add_f32 v12, v12, v131
  v_add_f32 v9, v9, v132
  v_add_f32 v10, v10, v133
  v_add_f32 v11, v11, v134
  v_add_f32 v12, v12, v135
  v_add_f32 v9, v9, v136
  v_add_f32 v10, v10, v137
  v_add_f32 v11, v11, v138
  v_add_f32 v12, v12, v139
  v_add_f32 v9, v9, v140
  v_add_f32 v10, v10, v141
  v_add_f32 v11, v11, v142
  v_add_f32 v12, v12, v143
  v_mov_b32 v13, 0
  v_mov_b32 v14, 0
  v_dot2_f32_bf16 v13, v16, v48, v13
  v_dot2_f32_bf16 v14, v17, v49, v14
  v_dot2_f32_bf16 v13, v18, v50, v13
  v_dot2_f32_bf16 v14, v19, v51, v14
  v_dot2_f32_bf16 v13, v20, v52, v13
  v_dot2_f32_bf16 v14, v21, v53, v14
  v_dot2_f32_bf16 v13, v22, v54, v13
  v_dot2_f32_bf16 v14, v23, v55, v14
  v_dot2_f32_bf16 v13, v24, v56, v13
  v_dot2_f32_bf16 v14, v25, v57, v14
  v_dot2_f32_bf16 v13, v26, v58, v13
  v_dot2_f32_bf16 v14, v27, v59, v14
  v_dot2_f32_bf16 v13, v28, v60, v13
  v_dot2_f32_bf16 v14, v29, v61, v14
  v_dot2_f32_bf16 v13, v30, v62, v13
  v_dot2_f32_bf16 v14, v31, v63, v14
  v_dot2_f32_bf16 v13, v32, v64, v13
  v_dot2_f32_bf16 v14, v33, v65, v14
  v_dot2_f32_bf16 v13, v34, v66, v13
  v_dot2_f32_bf16 v14, v35, v67, v14
  v_dot2_f32_bf16 v13, v36, v68, v13
  v_dot2_f32_bf16 v14, v37, v69, v14
  v_dot2_f32_bf16 v13, v38, v70, v13
  v_dot2_f32_bf16 v14, v39, v71, v14
  v_dot2_f32_bf16 v13, v40, v72, v13
  v_dot2_f32_bf16 v14, v41, v73, v14
  v_dot2_f32_bf16 v13, v42, v74, v13
  v_dot2_f32_bf16 v14, v43, v75, v14
  v_dot2_f32_bf16 v13, v44, v76, v13
  v_dot2_f32_bf16 v14, v45, v77, v14
  v_dot2_f32_bf16 v13, v46, v78, v13
  v_dot2_f32_bf16 v14, v47, v79, v14
  v_add_f32 v9, v9, v10
  v_add_f32 v11, v11, v12
  v_add_f32 v9, v9, v11
  s_nop 2
  v_add_f32 v13, v13, v14
  s_nop 1
  v_add_f32_dpp v9, v9, v9 quad_perm:[1,0,3,2] row_mask:0xf bank_mask:0xf
  s_nop 1
  v_add_f32_dpp v9, v9, v9 quad_perm:[2,3,0,1] row_mask:0xf bank_mask:0xf
  s_nop 1
  v_add_f32_dpp v9, v9, v9 row_half_mirror row_mask:0xf bank_mask:0xf
  s_nop 1
  v_add_f32_dpp v13, v13, v13 quad_perm:[1,0,3,2] row_mask:0xf bank_mask:0xf
  s_nop 1
  v_add_f32_dpp v13, v13, v13 quad_perm:[2,3,0,1] row_mask:0xf bank_mask:0xf
  s_nop 1
  v_add_f32_dpp v13, v13, v13 row_half_mirror row_mask:0xf bank_mask:0xf
  v_mul_f32 v9, 0x3b000000, v9
  v_sub_f32 v80, v80, v9
  v_sub_f32 v81, v81, v9
  v_sub_f32 v82, v82, v9
  v_sub_f32 v83, v83, v9
  v_sub_f32 v84, v84, v9
  v_sub_f32 v85, v85, v9
  v_sub_f32 v86, v86, v9
  v_sub_f32 v87, v87, v9
  v_sub_f32 v88, v88, v9
  v_sub_f32 v89, v89, v9
  v_sub_f32 v90, v90, v9
  v_sub_f32 v91, v91, v9
  v_sub_f32 v92, v92, v9
  v_sub_f32 v93, v93, v9
  v_sub_f32 v94, v94, v9
  v_sub_f32 v95, v95, v9
  v_sub_f32 v96, v96, v9
  v_sub_f32 v97, v97, v9
  v_sub_f32 v98, v98, v9
  v_sub_f32 v99, v99, v9
  v_sub_f32 v100, v100, v9
  v_sub_f32 v101, v101, v9
  v_sub_f32 v102, v102, v9
  v_sub_f32 v103, v103, v9
  v_sub_f32 v104, v104, v9
  v_sub_f32 v105, v105, v9
  v_sub_f32 v106, v106, v9
  v_sub_f32 v107, v107, v9
  v_sub_f32 v108, v108, v9
  v_sub_f32 v109, v109, v9
  v_sub_f32 v110, v110, v9
  v_sub_f32 v111, v111, v9
  v_sub_f32 v112, v112, v9
  v_sub_f32 v113, v113, v9
  v_sub_f32 v114, v114, v9
  v_sub_f32 v115, v115, v9
  v_sub_f32 v116, v116, v9
  v_sub_f32 v117, v117, v9
  v_sub_f32 v118, v118, v9
  v_sub_f32 v119, v119, v9
  v_sub_f32 v120, v120, v9
  v_sub_f32 v121, v121, v9
  v_sub_f32 v122, v122, v9
  v_sub_f32 v123, v123, v9
  v_sub_f32 v124, v124, v9
  v_sub_f32 v125, v125, v9
  v_sub_f32 v126, v126, v9
  v_sub_f32 v127, v127, v9
  v_sub_f32 v128, v128, v9
  v_sub_f32 v129, v129, v9
  v_sub_f32 v130, v130, v9
  v_sub_f32 v131, v131, v9
  v_sub_f32 v132, v132, v9
  v_sub_f32 v133, v133, v9
  v_sub_f32 v134, v134, v9
  v_sub_f32 v135, v135, v9
  v_sub_f32 v136, v136, v9
  v_sub_f32 v137, v137, v9
  v_sub_f32 v138, v138, v9
  v_sub_f32 v139, v139, v9
  v_sub_f32 v140, v140, v9
  v_sub_f32 v141, v141, v9
  v_sub_f32 v142, v142, v9
  v_sub_f32 v143, v143, v9
  v_mul_f32 v9, v80, v80
  v_mul_f32 v10, v81, v81
  v_mul_f32 v11, v82, v82
  v_mul_f32 v12, v83, v83
  v_fmac_f32 v9, v84, v84
  v_fmac_f32 v10, v85, v85
  v_fmac_f32 v11, v86, v86
  v_fmac_f32 v12, v87, v87
  v_fmac_f32 v9, v88, v88
  v_fmac_f32 v10, v89, v89
  v_fmac_f32 v11, v90, v90
  v_fmac_f32 v12, v91, v91
  v_fmac_f32 v9, v92, v92
  v_fmac_f32 v10, v93, v93
  v_fmac_f32 v11, v94, v94
  v_fmac_f32 v12, v95, v95
  v_fmac_f32 v9, v96, v96
  v_fmac_f32 v10, v97, v97
  v_fmac_f32 v11, v98, v98
  v_fmac_f32 v12, v99, v99
  v_fmac_f32 v9, v100, v100
  v_fmac_f32 v10, v101, v101
  v_fmac_f32 v11, v102, v102
  v_fmac_f32 v12, v103, v103
  v_fmac_f32 v9, v104, v104
  v_fmac_f32 v10, v105, v105
  v_fmac_f32 v11, v106, v106
  v_fmac_f32 v12, v107, v107
  v_fmac_f32 v9, v108, v108
  v_fmac_f32 v10, v109, v109
  v_fmac_f32 v11, v110, v110
  v_fmac_f32 v12, v111, v111
  v_fmac_f32 v9, v112, v112
  v_fmac_f32 v10, v113, v113
  v_fmac_f32 v11, v114, v114
  v_fmac_f32 v12, v115, v115
  v_fmac_f32 v9, v116, v116
  v_fmac_f32 v10, v117, v117
  v_fmac_f32 v11, v118, v118
  v_fmac_f32 v12, v119, v119
  v_fmac_f32 v9, v120, v120
  v_fmac_f32 v10, v121, v121
  v_fmac_f32 v11, v122, v122
  v_fmac_f32 v12, v123, v123
  v_fmac_f32 v9, v124, v124
  v_fmac_f32 v10, v125, v125
  v_fmac_f32 v11, v126, v126
  v_fmac_f32 v12, v127, v127
  v_fmac_f32 v9, v128, v128
  v_fmac_f32 v10, v129, v129
  v_fmac_f32 v11, v130, v130
  v_fmac_f32 v12, v131, v131
  v_fmac_f32 v9, v132, v132
  v_fmac_f32 v10, v133, v133
  v_fmac_f32 v11, v134, v134
  v_fmac_f32 v12, v135, v135
  v_fmac_f32 v9, v136, v136
  v_fmac_f32 v10, v137, v137
  v_fmac_f32 v11, v138, v138
  v_fmac_f32 v12, v139, v139
  v_fmac_f32 v9, v140, v140
  v_fmac_f32 v10, v141, v141
  v_fmac_f32 v11, v142, v142
  v_fmac_f32 v12, v143, v143
  v_add_f32 v9, v9, v10
  v_add_f32 v11, v11, v12
  v_add_f32 v9, v9, v11
  s_nop 1
  v_add_f32_dpp v9, v9, v9 quad_perm:[1,0,3,2] row_mask:0xf bank_mask:0xf
  s_nop 1
  v_add_f32_dpp v9, v9, v9 quad_perm:[2,3,0,1] row_mask:0xf bank_mask:0xf
  s_nop 1
  v_add_f32_dpp v9, v9, v9 row_half_mirror row_mask:0xf bank_mask:0xf
  v_mov_b32 v10, 0x3727c5ac
  v_fmac_f32 v10, 0x3b000000, v9
  v_rsq_f32 v10, v10
  v_mul_f32 v13, 0xbfb8aa3b, v13
  v_exp_f32 v13, v13
  s_nop 0
  v_add_f32 v13, 1.0, v13
  v_rcp_f32 v13, v13
  v_lshlrev_b32 v5, 2, v5
  v_add_u32 v5, 0x800000, v5
  v_cmp_eq_u32 vcc, 0, v4
  s_and_saveexec_b64 s[84:85], vcc
  buffer_store_dword v13, v5, s[12:15], 0 offen sc1
  s_mov_b64 exec, -1
  v_mul_f32 v80, v80, v10
  v_mul_f32 v81, v81, v10
  v_mul_f32 v82, v82, v10
  v_mul_f32 v83, v83, v10
  v_mul_f32 v84, v84, v10
  v_mul_f32 v85, v85, v10
  v_mul_f32 v86, v86, v10
  v_mul_f32 v87, v87, v10
  v_mul_f32 v88, v88, v10
  v_mul_f32 v89, v89, v10
  v_mul_f32 v90, v90, v10
  v_mul_f32 v91, v91, v10
  v_mul_f32 v92, v92, v10
  v_mul_f32 v93, v93, v10
  v_mul_f32 v94, v94, v10
  v_mul_f32 v95, v95, v10
  v_mul_f32 v96, v96, v10
  v_mul_f32 v97, v97, v10
  v_mul_f32 v98, v98, v10
  v_mul_f32 v99, v99, v10
  v_mul_f32 v100, v100, v10
  v_mul_f32 v101, v101, v10
  v_mul_f32 v102, v102, v10
  v_mul_f32 v103, v103, v10
  v_mul_f32 v104, v104, v10
  v_mul_f32 v105, v105, v10
  v_mul_f32 v106, v106, v10
  v_mul_f32 v107, v107, v10
  v_mul_f32 v108, v108, v10
  v_mul_f32 v109, v109, v10
  v_mul_f32 v110, v110, v10
  v_mul_f32 v111, v111, v10
  v_mul_f32 v112, v112, v10
  v_mul_f32 v113, v113, v10
  v_mul_f32 v114, v114, v10
  v_mul_f32 v115, v115, v10
  v_mul_f32 v116, v116, v10
  v_mul_f32 v117, v117, v10
  v_mul_f32 v118, v118, v10
  v_mul_f32 v119, v119, v10
  v_mul_f32 v120, v120, v10
  v_mul_f32 v121, v121, v10
  v_mul_f32 v122, v122, v10
  v_mul_f32 v123, v123, v10
  v_mul_f32 v124, v124, v10
  v_mul_f32 v125, v125, v10
  v_mul_f32 v126, v126, v10
  v_mul_f32 v127, v127, v10
  v_mul_f32 v128, v128, v10
  v_mul_f32 v129, v129, v10
  v_mul_f32 v130, v130, v10
  v_mul_f32 v131, v131, v10
  v_mul_f32 v132, v132, v10
  v_mul_f32 v133, v133, v10
  v_mul_f32 v134, v134, v10
  v_mul_f32 v135, v135, v10
  v_mul_f32 v136, v136, v10
  v_mul_f32 v137, v137, v10
  v_mul_f32 v138, v138, v10
  v_mul_f32 v139, v139, v10
  v_mul_f32 v140, v140, v10
  v_mul_f32 v141, v141, v10
  v_mul_f32 v142, v142, v10
  v_mul_f32 v143, v143, v10
  v_cvt_pk_bf16_f32 v16, v80, v81
  v_cvt_pk_bf16_f32 v17, v82, v83
  v_cvt_pk_bf16_f32 v18, v84, v85
  v_cvt_pk_bf16_f32 v19, v86, v87
  v_cvt_pk_bf16_f32 v20, v88, v89
  v_cvt_pk_bf16_f32 v21, v90, v91
  v_cvt_pk_bf16_f32 v22, v92, v93
  v_cvt_pk_bf16_f32 v23, v94, v95
  v_cvt_pk_bf16_f32 v24, v96, v97
  v_cvt_pk_bf16_f32 v25, v98, v99
  v_cvt_pk_bf16_f32 v26, v100, v101
  v_cvt_pk_bf16_f32 v27, v102, v103
  v_cvt_pk_bf16_f32 v28, v104, v105
  v_cvt_pk_bf16_f32 v29, v106, v107
  v_cvt_pk_bf16_f32 v30, v108, v109
  v_cvt_pk_bf16_f32 v31, v110, v111
  v_cvt_pk_bf16_f32 v32, v112, v113
  v_cvt_pk_bf16_f32 v33, v114, v115
  v_cvt_pk_bf16_f32 v34, v116, v117
  v_cvt_pk_bf16_f32 v35, v118, v119
  v_cvt_pk_bf16_f32 v36, v120, v121
  v_cvt_pk_bf16_f32 v37, v122, v123
  v_cvt_pk_bf16_f32 v38, v124, v125
  v_cvt_pk_bf16_f32 v39, v126, v127
  v_cvt_pk_bf16_f32 v40, v128, v129
  v_cvt_pk_bf16_f32 v41, v130, v131
  v_cvt_pk_bf16_f32 v42, v132, v133
  v_cvt_pk_bf16_f32 v43, v134, v135
  v_cvt_pk_bf16_f32 v44, v136, v137
  v_cvt_pk_bf16_f32 v45, v138, v139
  v_cvt_pk_bf16_f32 v46, v140, v141
  v_cvt_pk_bf16_f32 v47, v142, v143
  s_lshl_b32 s84, s3, 3
  v_add_u32 v3, s84, v3
  s_movk_i32 s85, 1088
  v_mul_lo_u32 v3, v3, s85
  v_add_u32 v3, v3, v6
  v_add_u32 v3, 40960, v3
  ds_write_b128 v3, v[16:19] offset:0
  ds_write_b128 v3, v[20:23] offset:128
  ds_write_b128 v3, v[24:27] offset:256
  ds_write_b128 v3, v[28:31] offset:384
  ds_write_b128 v3, v[32:35] offset:512
  ds_write_b128 v3, v[36:39] offset:640
  ds_write_b128 v3, v[40:43] offset:768
  ds_write_b128 v3, v[44:47] offset:896
  v_and_b32 v3, 15, v2
  v_lshrrev_b32 v4, 2, v3
  v_lshrrev_b32 v5, 5, v2
  v_lshl_add_u32 v4, v5, 2, v4
  v_bfe_u32 v5, v2, 4, 1
  v_lshlrev_b32 v5, 5, v5
  v_and_b32 v3, 3, v3
  v_lshl_add_u32 v5, v3, 3, v5
  s_movk_i32 s85, 1088
  v_mul_lo_u32 v6, v4, s85
  v_add_u32 v6, v6, v5
  s_lshl_b32 s84, s3, 8
  s_add_u32 s84, s84, 40960
  v_add_u32 v6, s84, v6
  s_lshl_b32 s83, s90, 11
  s_lshl_b32 s84, s3, 19
  s_add_u32 s84, s84, s83
  s_add_u32 s84, s84, 0x600000
  v_add_u32 v9, s84, v250
  s_waitcnt lgkmcnt(0)
  v_mov_b32 v10, 1
  s_mov_b64 exec, 1
  ds_add_u32 v251, v10 offset:24
  s_mov_b64 exec, -1
  s_mov_b32 s97, 0
L_lb_13:
  ds_read_b32 v11, v251 offset:24
  s_waitcnt lgkmcnt(0)
  v_readfirstlane_b32 s96, v11
  s_add_u32 s97, s97, 1
  s_cmp_ge_u32 s96, 4
  s_cbranch_scc1 L_lbd_14
  s_cmp_gt_u32 s97, 240000
  s_cbranch_scc1 L_lbd_14
  s_branch L_lb_13
L_lbd_14:
  ds_read_b64_tr_b16 v[16:17], v6 offset:0
  ds_read_b64_tr_b16 v[18:19], v6 offset:8704
  ds_read_b64_tr_b16 v[20:21], v6 offset:17408
  ds_read_b64_tr_b16 v[22:23], v6 offset:26112
  ds_read_b64_tr_b16 v[24:25], v6 offset:64
  ds_read_b64_tr_b16 v[26:27], v6 offset:8768
  ds_read_b64_tr_b16 v[28:29], v6 offset:17472
  ds_read_b64_tr_b16 v[30:31], v6 offset:26176
  ds_read_b64_tr_b16 v[32:33], v6 offset:128
  ds_read_b64_tr_b16 v[34:35], v6 offset:8832
  ds_read_b64_tr_b16 v[36:37], v6 offset:17536
  ds_read_b64_tr_b16 v[38:39], v6 offset:26240
  ds_read_b64_tr_b16 v[40:41], v6 offset:192
  ds_read_b64_tr_b16 v[42:43], v6 offset:8896
  ds_read_b64_tr_b16 v[44:45], v6 offset:17600
  ds_read_b64_tr_b16 v[46:47], v6 offset:26304
  s_waitcnt lgkmcnt(0)
  v_mov_b32 v10, 1
  s_mov_b64 exec, 1
  ds_add_u32 v251, v10 offset:28
  s_mov_b64 exec, -1
  s_mov_b32 s85, 0
  buffer_store_dwordx4 v[16:19], v9, s[12:15], s85 offen offset:0 sc1
  s_mov_b32 s85, 0
  buffer_store_dwordx4 v[20:23], v9, s[12:15], s85 offen offset:1024 sc1
  s_mov_b32 s85, 131072
  buffer_store_dwordx4 v[24:27], v9, s[12:15], s85 offen offset:0 sc1
  s_mov_b32 s85, 131072
  buffer_store_dwordx4 v[28:31], v9, s[12:15], s85 offen offset:1024 sc1
  s_mov_b32 s85, 262144
  buffer_store_dwordx4 v[32:35], v9, s[12:15], s85 offen offset:0 sc1
  s_mov_b32 s85, 262144
  buffer_store_dwordx4 v[36:39], v9, s[12:15], s85 offen offset:1024 sc1
  s_mov_b32 s85, 393216
  buffer_store_dwordx4 v[40:43], v9, s[12:15], s85 offen offset:0 sc1
  s_mov_b32 s85, 393216
  buffer_store_dwordx4 v[44:47], v9, s[12:15], s85 offen offset:1024 sc1
  s_waitcnt vmcnt(9)
  v_readfirstlane_b32 s68, v144
  v_readfirstlane_b32 s69, v145
  s_cmp_lg_u32 s68, 0
  s_cbranch_scc1 L_tokok_15
  s_mov_b32 s97, 0
L_tok_16:
  buffer_load_dwordx2 v[144:145], v252, s[64:67], 0 offen sc1
  s_waitcnt vmcnt(0)
  v_readfirstlane_b32 s68, v144
  v_readfirstlane_b32 s69, v145
  s_add_u32 s97, s97, 1
  s_cmp_lg_u32 s68, 0
  s_cbranch_scc1 L_tokd_17
  s_cmp_gt_u32 s97, 60000
  s_cbranch_scc1 L_tokd_17
  s_sleep 1
  s_branch L_tok_16
L_tokd_17:
L_tokok_15:
  s_lshl_b32 s83, s90, 2
  s_add_u32 s83, s83, s3
  s_lshl_b32 s83, s83, 6
  s_add_u32 s83, s83, 0xd00000
  s_mov_b32 s91, s83
  v_mov_b32 v144, s68
  v_mov_b32 v145, s69
  s_waitcnt vmcnt(0)
  s_mov_b64 exec, 1
  buffer_store_dwordx2 v[144:145], v252, s[12:15], s83 offen sc1
  s_mov_b64 exec, -1
  v_mov_b32 v10, 1
  s_mov_b64 exec, 1
  ds_add_u32 v251, v10 offset:32
  s_mov_b64 exec, -1
  s_mov_b32 s97, 0
L_lw_18:
  ds_read_b32 v11, v251 offset:28
  s_waitcnt lgkmcnt(0)
  v_readfirstlane_b32 s96, v11
  s_add_u32 s97, s97, 1
  s_cmp_ge_u32 s96, 4
  s_cbranch_scc1 L_lwd_19
  s_cmp_gt_u32 s97, 240000
  s_cbranch_scc1 L_lwd_19
  s_branch L_lw_18
L_lwd_19:
L_nou:
  s_lshl_b32 s91, s2, 2
  s_add_u32 s91, s91, s3
  s_lshl_b32 s91, s91, 6
  s_add_u32 s91, s91, 0xd2ee00
  s_sub_u32 s83, s82, 22
  s_lshl_b32 s83, s83, 2
  s_add_u32 s83, s83, s3
  v_lshrrev_b32 v3, 2, v2
  v_and_b32 v4, 3, v2
  s_lshl_b32 s84, s83, 4
  v_add_u32 v3, s84, v3
  v_lshlrev_b32 v3, 12, v3
  v_lshl_add_u32 v3, v4, 7, v3
  s_lshl_b32 s84, s81, 9
  v_add_u32 v3, s84, v3
  s_lshl_b32 s84, s83, 13
  v_lshlrev_b32 v4, 7, v2
  v_add_u32 v4, s84, v4
  s_mov_b32 s97, 0
L_lw_20:
  ds_read_b32 v11, v251 offset:20
  s_waitcnt lgkmcnt(0)
  v_readfirstlane_b32 s96, v11
  s_add_u32 s97, s97, 1
  s_cmp_ge_u32 s96, 4
  s_cbranch_scc1 L_lwd_21
  s_cmp_gt_u32 s97, 240000
  s_cbranch_scc1 L_lwd_21
  s_branch L_lw_20
L_lwd_21:
  s_lshl_b32 s87, s46, 16
  s_add_u32 m0, s76, 0
  s_add_u32 s46, s46, 1
  buffer_load_dwordx4 v242, s[20:23], s87 offen lds
  s_add_u32 m0, s76, 1024
  s_cmp_eq_u32 s46, 22
  s_cselect_b32 s46, 0, s46
  buffer_load_dwordx4 v243, s[20:23], s87 offen lds
  s_lshl_b32 s87, s46, 16
  s_add_u32 m0, s76, 2048
  s_add_u32 s46, s46, 1
  buffer_load_dwordx4 v242, s[20:23], s87 offen lds
  s_add_u32 m0, s76, 3072
  s_cmp_eq_u32 s46, 22
  s_cselect_b32 s46, 0, s46
  buffer_load_dwordx4 v243, s[20:23], s87 offen lds
  s_lshl_b32 s87, s46, 16
  s_add_u32 m0, s76, 4096
  s_add_u32 s46, s46, 1
  buffer_load_dwordx4 v242, s[20:23], s87 offen lds
  s_add_u32 m0, s76, 5120
  s_cmp_eq_u32 s46, 22
  s_cselect_b32 s46, 0, s46
  buffer_load_dwordx4 v243, s[20:23], s87 offen lds
  s_lshl_b32 s87, s46, 16
  s_add_u32 m0, s76, 6144
  s_add_u32 s46, s46, 1
  buffer_load_dwordx4 v242, s[20:23], s87 offen lds
  s_add_u32 m0, s76, 7168
  s_cmp_eq_u32 s46, 22
  s_cselect_b32 s46, 0, s46
  buffer_load_dwordx4 v243, s[20:23], s87 offen lds
  s_lshl_b32 s87, s46, 16
  s_add_u32 m0, s77, 0
  s_add_u32 s46, s46, 1
  buffer_load_dwordx4 v242, s[20:23], s87 offen lds
  s_add_u32 m0, s77, 1024
  s_cmp_eq_u32 s46, 22
  s_cselect_b32 s46, 0, s46
  buffer_load_dwordx4 v243, s[20:23], s87 offen lds
  s_lshl_b32 s87, s46, 16
  s_add_u32 m0, s77, 2048
  s_add_u32 s46, s46, 1
  buffer_load_dwordx4 v242, s[20:23], s87 offen lds
  s_add_u32 m0, s77, 3072
  s_cmp_eq_u32 s46, 22
  s_cselect_b32 s46, 0, s46
  buffer_load_dwordx4 v243, s[20:23], s87 offen lds
  s_lshl_b32 s87, s46, 16
  s_add_u32 m0, s77, 4096
  s_add_u32 s46, s46, 1
  buffer_load_dwordx4 v242, s[20:23], s87 offen lds
  s_add_u32 m0, s77, 5120
  s_cmp_eq_u32 s46, 22
  s_cselect_b32 s46, 0, s46
  buffer_load_dwordx4 v243, s[20:23], s87 offen lds
L_ystart:
  s_mov_b32 s36, s54
  s_and_b32 s37, s55, 0xffff
  s_mov_b32 s38, 0x1000
  s_mov_b32 s39, 0x00020000
  v_min_u32 v3, 21, v2
  v_lshrrev_b32 v4, 1, v3
  s_mul_i32 s83, s3, 11
  v_add_u32 v4, s83, v4
  v_min_u32 v4, 42, v4
  v_lshlrev_b32 v4, 4, v4
  v_and_b32 v3, 1, v3
  s_lshl_b32 s83, s73, 1
  v_add3_u32 v3, v3, v4, s83
  v_lshlrev_b32 v3, 6, v3
  v_add_u32 v3, 0xd10000, v3
  v_subrev_u32 v4, 22, v2
  v_and_b32 v4, 7, v4
  s_lshl_b32 s83, s72, 3
  v_add_u32 v4, s83, v4
  v_lshlrev_b32 v4, 6, v4
  v_add_u32 v4, 0xd00000, v4
  v_cmp_lt_u32 vcc, 21, v2
  s_nop 1
  v_cndmask_b32 v3, v3, v4, vcc
  buffer_load_dwordx2 v[4:5], v3, s[12:15], 0 offen sc1
  s_lshl_b32 s87, s46, 16
  s_add_u32 m0, s77, 6144
  s_add_u32 s46, s46, 1
  buffer_load_dwordx4 v242, s[20:23], s87 offen lds
  s_add_u32 m0, s77, 7168
  s_cmp_eq_u32 s46, 22
  s_cselect_b32 s46, 0, s46
  buffer_load_dwordx4 v243, s[20:23], s87 offen lds
  s_lshl_b32 s87, s46, 16
  s_add_u32 m0, s77, 8192
  s_add_u32 s46, s46, 1
  buffer_load_dwordx4 v242, s[20:23], s87 offen lds
  s_add_u32 m0, s77, 9216
  s_cmp_eq_u32 s46, 22
  s_cselect_b32 s46, 0, s46
  buffer_load_dwordx4 v243, s[20:23], s87 offen lds
  s_lshl_b32 s87, s46, 16
  s_add_u32 m0, s77, 10240
  s_add_u32 s46, s46, 1
  buffer_load_dwordx4 v242, s[20:23], s87 offen lds
  s_add_u32 m0, s77, 11264
  s_cmp_eq_u32 s46, 22
  s_cselect_b32 s46, 0, s46
  buffer_load_dwordx4 v243, s[20:23], s87 offen lds
  s_lshl_b32 s87, s46, 16
  s_add_u32 m0, s77, 12288
  s_add_u32 s46, s46, 1
  buffer_load_dwordx4 v242, s[20:23], s87 offen lds
  s_add_u32 m0, s77, 13312
  s_cmp_eq_u32 s46, 22
  s_cselect_b32 s46, 0, s46
  buffer_load_dwordx4 v243, s[20:23], s87 offen lds
  s_lshl_b32 s87, s46, 16
  s_add_u32 m0, s77, 14336
  s_add_u32 s46, s46, 1
  buffer_load_dwordx4 v242, s[20:23], s87 offen lds
  s_add_u32 m0, s77, 15360
  s_cmp_eq_u32 s46, 22
  s_cselect_b32 s46, 0, s46
  buffer_load_dwordx4 v243, s[20:23], s87 offen lds
  s_lshl_b32 s87, s46, 16
  s_add_u32 m0, s74, 0
  s_add_u32 s46, s46, 1
  buffer_load_dwordx4 v242, s[20:23], s87 offen lds
  s_add_u32 m0, s74, 1024
  s_cmp_eq_u32 s46, 22
  s_cselect_b32 s46, 0, s46
  buffer_load_dwordx4 v243, s[20:23], s87 offen lds
  s_lshl_b32 s87, s46, 16
  s_add_u32 m0, s74, 2048
  s_add_u32 s46, s46, 1
  buffer_load_dwordx4 v242, s[20:23], s87 offen lds
  s_add_u32 m0, s74, 3072
  s_cmp_eq_u32 s46, 22
  s_cselect_b32 s46, 0, s46
  buffer_load_dwordx4 v243, s[20:23], s87 offen lds
  s_lshl_b32 s87, s46, 16
  s_add_u32 m0, s74, 4096
  s_add_u32 s46, s46, 1
  buffer_load_dwordx4 v242, s[20:23], s87 offen lds
  s_add_u32 m0, s74, 5120
  s_cmp_eq_u32 s46, 22
  s_cselect_b32 s46, 0, s46
  buffer_load_dwordx4 v243, s[20:23], s87 offen lds
  s_lshl_b32 s87, s46, 16
  s_add_u32 m0, s74, 6144
  s_add_u32 s46, s46, 1
  buffer_load_dwordx4 v242, s[20:23], s87 offen lds
  s_add_u32 m0, s74, 7168
  s_cmp_eq_u32 s46, 22
  s_cselect_b32 s46, 0, s46
  buffer_load_dwordx4 v243, s[20:23], s87 offen lds
  s_lshl_b32 s87, s46, 16
  s_add_u32 m0, s74, 8192
  s_add_u32 s46, s46, 1
  buffer_load_dwordx4 v242, s[20:23], s87 offen lds
  s_add_u32 m0, s74, 9216
  s_cmp_eq_u32 s46, 22
  s_cselect_b32 s46, 0, s46
  buffer_load_dwordx4 v243, s[20:23], s87 offen lds
  v_and_b32 v8, 7, v2
  s_lshl_b32 s83, s3, 3
  v_add_u32 v8, s83, v8
  v_lshlrev_b32 v8, 5, v8
  v_add_u32 v8, s72, v8
  v_lshlrev_b32 v8, 6, v8
  v_add_u32 v8, 0xd1c000, v8
  s_mul_i32 s83, s3, 360448
  s_lshl_b32 s84, s73, 11
  s_add_u32 s83, s83, s84
  v_add_u32 v12, s83, v250
  s_lshl_b32 s83, s72, 16
  s_lshl_b32 s84, s3, 13
  s_add_u32 s83, s83, s84
  s_add_u32 s83, s83, 0x900000
  v_add_u32 v13, s83, v250
  v_add_u32 v14, 0x8000, v13
  v_and_b32 v7, 31, v2
  s_lshl_b32 s83, s72, 6
  v_add_u32 v7, s83, v7
  v_lshlrev_b32 v9, 1, v7
  buffer_load_ushort v226, v9, s[36:39], 0 offen
  buffer_load_ushort v227, v9, s[36:39], 0 offen offset:64
  s_waitcnt vmcnt(22)
  s_mov_b32 s97, 0
  v_cmp_eq_u64 vcc, s[68:69], v[4:5]
  s_cmp_eq_u64 vcc, exec
  s_cbranch_scc1 L_fld_25
  s_andn2_b64 s[94:95], exec, vcc
  s_ff1_i32_b64 s96, s[94:95]
  s_lshl_b64 s[94:95], 1, s96
  s_mov_b64 exec, s[94:95]
L_fl1_23:
  s_sleep 1
  buffer_load_dwordx2 v[4:5], v3, s[12:15], 0 offen sc1
  s_add_u32 s97, s97, 1
  s_waitcnt vmcnt(0)
  v_cmp_eq_u64 vcc, s[68:69], v[4:5]
  s_cmp_eq_u64 vcc, exec
  s_cbranch_scc1 L_fl2_24
  s_cmp_gt_u32 s97, 60000
  s_cbranch_scc0 L_fl1_23
L_fl2_24:
  s_mov_b64 exec, -1
L_fl_22:
  v_cmp_eq_u64 vcc, s[68:69], v[4:5]
  s_cmp_eq_u64 vcc, exec
  s_cbranch_scc1 L_fld_25
  s_add_u32 s97, s97, 1
  s_cmp_gt_u32 s97, 60000
  s_cbranch_scc1 L_fld_25
  s_andn2_b64 exec, exec, vcc
  buffer_load_dwordx2 v[4:5], v3, s[12:15], 0 offen sc1
  s_mov_b64 exec, -1
  s_waitcnt vmcnt(0)
  s_branch L_fl_22
L_fld_25:
  v_lshlrev_b32 v9, 2, v7
  v_add_u32 v9, 0x800000, v9
  buffer_load_dword v224, v9, s[12:15], 0 offen sc1
  buffer_load_dword v225, v9, s[12:15], 0 offen offset:128 sc1
  s_lshl_b32 s86, s47, 14
  buffer_load_dwordx4 v[16:19], v12, s[28:31], s86 offen sc1
  s_add_u32 s47, s47, 1
  buffer_load_dwordx4 v[20:23], v12, s[28:31], s86 offen offset:1024 sc1
  s_cmp_eq_u32 s47, 22
  s_cselect_b32 s47, 0, s47
  s_lshl_b32 s86, s47, 14
  buffer_load_dwordx4 v[24:27], v12, s[28:31], s86 offen sc1
  s_add_u32 s47, s47, 1
  buffer_load_dwordx4 v[28:31], v12, s[28:31], s86 offen offset:1024 sc1
  s_cmp_eq_u32 s47, 22
  s_cselect_b32 s47, 0, s47
  s_lshl_b32 s86, s47, 14
  buffer_load_dwordx4 v[32:35], v12, s[28:31], s86 offen sc1
  s_add_u32 s47, s47, 1
  buffer_load_dwordx4 v[36:39], v12, s[28:31], s86 offen offset:1024 sc1
  s_cmp_eq_u32 s47, 22
  s_cselect_b32 s47, 0, s47
  s_lshl_b32 s86, s47, 14
  buffer_load_dwordx4 v[40:43], v12, s[28:31], s86 offen sc1
  s_add_u32 s47, s47, 1
  buffer_load_dwordx4 v[44:47], v12, s[28:31], s86 offen offset:1024 sc1
  s_cmp_eq_u32 s47, 22
  s_cselect_b32 s47, 0, s47
  s_lshl_b32 s86, s47, 14
  buffer_load_dwordx4 v[48:51], v12, s[28:31], s86 offen sc1
  s_add_u32 s47, s47, 1
  buffer_load_dwordx4 v[52:55], v12, s[28:31], s86 offen offset:1024 sc1
  s_cmp_eq_u32 s47, 22
  s_cselect_b32 s47, 0, s47
  s_lshl_b32 s86, s47, 14
  buffer_load_dwordx4 v[56:59], v12, s[28:31], s86 offen sc1
  s_add_u32 s47, s47, 1
  buffer_load_dwordx4 v[60:63], v12, s[28:31], s86 offen offset:1024 sc1
  s_cmp_eq_u32 s47, 22
  s_cselect_b32 s47, 0, s47
  s_lshl_b32 s86, s47, 14
  buffer_load_dwordx4 v[64:67], v12, s[28:31], s86 offen sc1
  s_add_u32 s47, s47, 1
  buffer_load_dwordx4 v[68:71], v12, s[28:31], s86 offen offset:1024 sc1
  s_cmp_eq_u32 s47, 22
  s_cselect_b32 s47, 0, s47
  s_lshl_b32 s86, s47, 14
  buffer_load_dwordx4 v[72:75], v12, s[28:31], s86 offen sc1
  s_add_u32 s47, s47, 1
  buffer_load_dwordx4 v[76:79], v12, s[28:31], s86 offen offset:1024 sc1
  s_cmp_eq_u32 s47, 22
  s_cselect_b32 s47, 0, s47
  s_waitcnt vmcnt(14)
  ds_read_b64_tr_b16 v[80:81], v232 offset:0
  ds_read_b64_tr_b16 v[82:83], v232 offset:1024
  ds_read_b64_tr_b16 v[84:85], v233 offset:0
  ds_read_b64_tr_b16 v[86:87], v233 offset:1024
  s_waitcnt vmcnt(12) lgkmcnt(0)
  v_mfma_f32_32x32x16_bf16 v[96:111], v[16:19], v[80:83], 0
  ds_read_b64_tr_b16 v[88:89], v232 offset:2048
  ds_read_b64_tr_b16 v[90:91], v232 offset:3072
  v_mfma_f32_32x32x16_bf16 v[112:127], v[20:23], v[80:83], 0
  ds_read_b64_tr_b16 v[92:93], v233 offset:2048
  ds_read_b64_tr_b16 v[94:95], v233 offset:3072
  v_mfma_f32_32x32x16_bf16 v[128:143], v[16:19], v[84:87], 0
  s_lshl_b32 s87, s46, 16
  s_add_u32 m0, s76, 0
  s_add_u32 s46, s46, 1
  buffer_load_dwordx4 v242, s[20:23], s87 offen lds
  s_add_u32 m0, s76, 1024
  s_cmp_eq_u32 s46, 22
  s_cselect_b32 s46, 0, s46
  buffer_load_dwordx4 v243, s[20:23], s87 offen lds
  v_mfma_f32_32x32x16_bf16 v[144:159], v[20:23], v[84:87], 0
  s_lshl_b32 s86, s47, 14
  buffer_load_dwordx4 v[16:19], v12, s[28:31], s86 offen sc1
  s_add_u32 s47, s47, 1
  buffer_load_dwordx4 v[20:23], v12, s[28:31], s86 offen offset:1024 sc1
  s_cmp_eq_u32 s47, 22
  s_cselect_b32 s47, 0, s47
  s_waitcnt vmcnt(14) lgkmcnt(0)
  v_mfma_f32_32x32x16_bf16 v[96:111], v[24:27], v[88:91], v[96:111]
  ds_read_b64_tr_b16 v[80:81], v232 offset:4096
  ds_read_b64_tr_b16 v[82:83], v232 offset:5120
  v_mfma_f32_32x32x16_bf16 v[112:127], v[28:31], v[88:91], v[112:127]
  ds_read_b64_tr_b16 v[84:85], v233 offset:4096
  ds_read_b64_tr_b16 v[86:87], v233 offset:5120
  v_mfma_f32_32x32x16_bf16 v[128:143], v[24:27], v[92:95], v[128:143]
  s_lshl_b32 s87, s46, 16
  s_add_u32 m0, s76, 2048
  s_add_u32 s46, s46, 1
  buffer_load_dwordx4 v242, s[20:23], s87 offen lds
  s_add_u32 m0, s76, 3072
  s_cmp_eq_u32 s46, 22
  s_cselect_b32 s46, 0, s46
  buffer_load_dwordx4 v243, s[20:23], s87 offen lds
  v_mfma_f32_32x32x16_bf16 v[144:159], v[28:31], v[92:95], v[144:159]
  s_lshl_b32 s86, s47, 14
  buffer_load_dwordx4 v[24:27], v12, s[28:31], s86 offen sc1
  s_add_u32 s47, s47, 1
  buffer_load_dwordx4 v[28:31], v12, s[28:31], s86 offen offset:1024 sc1
  s_cmp_eq_u32 s47, 22
  s_cselect_b32 s47, 0, s47
  s_waitcnt vmcnt(16) lgkmcnt(0)
  v_mfma_f32_32x32x16_bf16 v[96:111], v[32:35], v[80:83], v[96:111]
  ds_read_b64_tr_b16 v[88:89], v232 offset:6144
  ds_read_b64_tr_b16 v[90:91], v232 offset:7168
  v_mfma_f32_32x32x16_bf16 v[112:127], v[36:39], v[80:83], v[112:127]
  ds_read_b64_tr_b16 v[92:93], v233 offset:6144
  ds_read_b64_tr_b16 v[94:95], v233 offset:7168
  v_mfma_f32_32x32x16_bf16 v[128:143], v[32:35], v[84:87], v[128:143]
  s_lshl_b32 s87, s46, 16
  s_add_u32 m0, s76, 4096
  s_add_u32 s46, s46, 1
  buffer_load_dwordx4 v242, s[20:23], s87 offen lds
  s_add_u32 m0, s76, 5120
  s_cmp_eq_u32 s46, 22
  s_cselect_b32 s46, 0, s46
  buffer_load_dwordx4 v243, s[20:23], s87 offen lds
  v_mfma_f32_32x32x16_bf16 v[144:159], v[36:39], v[84:87], v[144:159]
  s_lshl_b32 s86, s47, 14
  buffer_load_dwordx4 v[32:35], v12, s[28:31], s86 offen sc1
  s_add_u32 s47, s47, 1
  buffer_load_dwordx4 v[36:39], v12, s[28:31], s86 offen offset:1024 sc1
  s_cmp_eq_u32 s47, 22
  s_cselect_b32 s47, 0, s47
  s_waitcnt vmcnt(18) lgkmcnt(0)
  v_mfma_f32_32x32x16_bf16 v[96:111], v[40:43], v[88:91], v[96:111]
  ds_read_b64_tr_b16 v[80:81], v234 offset:0
  ds_read_b64_tr_b16 v[82:83], v234 offset:1024
  v_mfma_f32_32x32x16_bf16 v[112:127], v[44:47], v[88:91], v[112:127]
  ds_read_b64_tr_b16 v[84:85], v235 offset:0
  ds_read_b64_tr_b16 v[86:87], v235 offset:1024
  v_mfma_f32_32x32x16_bf16 v[128:143], v[40:43], v[92:95], v[128:143]
  s_lshl_b32 s87, s46, 16
  s_add_u32 m0, s76, 6144
  s_add_u32 s46, s46, 1
  buffer_load_dwordx4 v242, s[20:23], s87 offen lds
  s_add_u32 m0, s76, 7168
  s_cmp_eq_u32 s46, 22
  s_cselect_b32 s46, 0, s46
  buffer_load_dwordx4 v243, s[20:23], s87 offen lds
  v_mfma_f32_32x32x16_bf16 v[144:159], v[44:47], v[92:95], v[144:159]
  s_lshl_b32 s86, s47, 14
  buffer_load_dwordx4 v[40:43], v12, s[28:31], s86 offen sc1
  s_add_u32 s47, s47, 1
  buffer_load_dwordx4 v[44:47], v12, s[28:31], s86 offen offset:1024 sc1
  s_cmp_eq_u32 s47, 22
  s_cselect_b32 s47, 0, s47
  s_waitcnt vmcnt(20) lgkmcnt(0)
  v_mfma_f32_32x32x16_bf16 v[96:111], v[48:51], v[80:83], v[96:111]
  ds_read_b64_tr_b16 v[88:89], v234 offset:2048
  ds_read_b64_tr_b16 v[90:91], v234 offset:3072
  v_mfma_f32_32x32x16_bf16 v[112:127], v[52:55], v[80:83], v[112:127]
  ds_read_b64_tr_b16 v[92:93], v235 offset:2048
  ds_read_b64_tr_b16 v[94:95], v235 offset:3072
  v_mfma_f32_32x32x16_bf16 v[128:143], v[48:51], v[84:87], v[128:143]
  s_lshl_b32 s87, s46, 16
  s_add_u32 m0, s77, 0
  s_add_u32 s46, s46, 1
  buffer_load_dwordx4 v242, s[20:23], s87 offen lds
  s_add_u32 m0, s77, 1024
  s_cmp_eq_u32 s46, 22
  s_cselect_b32 s46, 0, s46
  buffer_load_dwordx4 v243, s[20:23], s87 offen lds
  v_mfma_f32_32x32x16_bf16 v[144:159], v[52:55], v[84:87], v[144:159]
  s_lshl_b32 s86, s47, 14
  buffer_load_dwordx4 v[48:51], v12, s[28:31], s86 offen sc1
  s_add_u32 s47, s47, 1
  buffer_load_dwordx4 v[52:55], v12, s[28:31], s86 offen offset:1024 sc1
  s_cmp_eq_u32 s47, 22
  s_cselect_b32 s47, 0, s47
  s_waitcnt vmcnt(22) lgkmcnt(0)
  v_mfma_f32_32x32x16_bf16 v[96:111], v[56:59], v[88:91], v[96:111]
  ds_read_b64_tr_b16 v[80:81], v234 offset:4096
  ds_read_b64_tr_b16 v[82:83], v234 offset:5120
  v_mfma_f32_32x32x16_bf16 v[112:127], v[60:63], v[88:91], v[112:127]
  ds_read_b64_tr_b16 v[84:85], v235 offset:4096
  ds_read_b64_tr_b16 v[86:87], v235 offset:5120
  v_mfma_f32_32x32x16_bf16 v[128:143], v[56:59], v[92:95], v[128:143]
  s_lshl_b32 s87, s44, 14
  s_add_u32 m0, s77, 2048
  s_add_u32 s44, s44, 1
  buffer_load_dwordx4 v244, s[24:27], s87 offen lds
  s_add_u32 m0, s77, 3072
  s_and_b32 s44, s44, 7
  buffer_load_dwordx4 v245, s[24:27], s87 offen lds
  v_mfma_f32_32x32x16_bf16 v[144:159], v[60:63], v[92:95], v[144:159]
  s_lshl_b32 s86, s47, 14
  buffer_load_dwordx4 v[56:59], v12, s[28:31], s86 offen sc1
  s_add_u32 s47, s47, 1
  buffer_load_dwordx4 v[60:63], v12, s[28:31], s86 offen offset:1024 sc1
  s_cmp_eq_u32 s47, 22
  s_cselect_b32 s47, 0, s47
  s_waitcnt vmcnt(24) lgkmcnt(0)
  v_mfma_f32_32x32x16_bf16 v[96:111], v[64:67], v[80:83], v[96:111]
  ds_read_b64_tr_b16 v[88:89], v234 offset:6144
  ds_read_b64_tr_b16 v[90:91], v234 offset:7168
  v_mfma_f32_32x32x16_bf16 v[112:127], v[68:71], v[80:83], v[112:127]
  ds_read_b64_tr_b16 v[92:93], v235 offset:6144
  ds_read_b64_tr_b16 v[94:95], v235 offset:7168
  v_mfma_f32_32x32x16_bf16 v[128:143], v[64:67], v[84:87], v[128:143]
  s_lshl_b32 s87, s44, 14
  s_add_u32 m0, s77, 4096
  s_add_u32 s44, s44, 1
  buffer_load_dwordx4 v244, s[24:27], s87 offen lds
  s_add_u32 m0, s77, 5120
  s_and_b32 s44, s44, 7
  buffer_load_dwordx4 v245, s[24:27], s87 offen lds
  v_mfma_f32_32x32x16_bf16 v[144:159], v[68:71], v[84:87], v[144:159]
  s_lshl_b32 s86, s47, 14
  buffer_load_dwordx4 v[64:67], v12, s[28:31], s86 offen sc1
  s_add_u32 s47, s47, 1
  buffer_load_dwordx4 v[68:71], v12, s[28:31], s86 offen offset:1024 sc1
  s_cmp_eq_u32 s47, 22
  s_cselect_b32 s47, 0, s47
  s_waitcnt vmcnt(24) lgkmcnt(0)
  v_mfma_f32_32x32x16_bf16 v[96:111], v[72:75], v[88:91], v[96:111]
  ds_read_b64_tr_b16 v[80:81], v234 offset:8192
  ds_read_b64_tr_b16 v[82:83], v234 offset:9216
  v_mfma_f32_32x32x16_bf16 v[112:127], v[76:79], v[88:91], v[112:127]
  ds_read_b64_tr_b16 v[84:85], v235 offset:8192
  ds_read_b64_tr_b16 v[86:87], v235 offset:9216
  v_mfma_f32_32x32x16_bf16 v[128:143], v[72:75], v[92:95], v[128:143]
  s_lshl_b32 s87, s44, 14
  s_add_u32 m0, s77, 6144
  s_add_u32 s44, s44, 1
  buffer_load_dwordx4 v244, s[24:27], s87 offen lds
  s_add_u32 m0, s77, 7168
  s_and_b32 s44, s44, 7
  buffer_load_dwordx4 v245, s[24:27], s87 offen lds
  v_mfma_f32_32x32x16_bf16 v[144:159], v[76:79], v[92:95], v[144:159]
  s_lshl_b32 s86, s47, 14
  buffer_load_dwordx4 v[72:75], v12, s[28:31], s86 offen sc1
  s_add_u32 s47, s47, 1
  buffer_load_dwordx4 v[76:79], v12, s[28:31], s86 offen offset:1024 sc1
  s_cmp_eq_u32 s47, 22
  s_cselect_b32 s47, 0, s47
  s_waitcnt vmcnt(24) lgkmcnt(0)
  v_mfma_f32_32x32x16_bf16 v[96:111], v[16:19], v[80:83], v[96:111]
  ds_read_b64_tr_b16 v[88:89], v234 offset:10240
  ds_read_b64_tr_b16 v[90:91], v234 offset:11264
  v_mfma_f32_32x32x16_bf16 v[112:127], v[20:23], v[80:83], v[112:127]
  ds_read_b64_tr_b16 v[92:93], v235 offset:10240
  ds_read_b64_tr_b16 v[94:95], v235 offset:11264
  v_mfma_f32_32x32x16_bf16 v[128:143], v[16:19], v[84:87], v[128:143]
  s_lshl_b32 s87, s44, 14
  s_add_u32 m0, s77, 8192
  s_add_u32 s44, s44, 1
  buffer_load_dwordx4 v244, s[24:27], s87 offen lds
  s_add_u32 m0, s77, 9216
  s_and_b32 s44, s44, 7
  buffer_load_dwordx4 v245, s[24:27], s87 offen lds
  v_mfma_f32_32x32x16_bf16 v[144:159], v[20:23], v[84:87], v[144:159]
  s_lshl_b32 s86, s47, 14
  buffer_load_dwordx4 v[16:19], v12, s[28:31], s86 offen sc1
  s_add_u32 s47, s47, 1
  buffer_load_dwordx4 v[20:23], v12, s[28:31], s86 offen offset:1024 sc1
  s_cmp_eq_u32 s47, 22
  s_cselect_b32 s47, 0, s47
  s_waitcnt vmcnt(24) lgkmcnt(0)
  v_mfma_f32_32x32x16_bf16 v[96:111], v[24:27], v[88:91], v[96:111]
  ds_read_b64_tr_b16 v[80:81], v234 offset:12288
  ds_read_b64_tr_b16 v[82:83], v234 offset:13312
  v_mfma_f32_32x32x16_bf16 v[112:127], v[28:31], v[88:91], v[112:127]
  ds_read_b64_tr_b16 v[84:85], v235 offset:12288
  ds_read_b64_tr_b16 v[86:87], v235 offset:13312
  v_mfma_f32_32x32x16_bf16 v[128:143], v[24:27], v[92:95], v[128:143]
  s_lshl_b32 s87, s44, 14
  s_add_u32 m0, s77, 10240
  s_add_u32 s44, s44, 1
  buffer_load_dwordx4 v244, s[24:27], s87 offen lds
  s_add_u32 m0, s77, 11264
  s_and_b32 s44, s44, 7
  buffer_load_dwordx4 v245, s[24:27], s87 offen lds
  v_mfma_f32_32x32x16_bf16 v[144:159], v[28:31], v[92:95], v[144:159]
  s_lshl_b32 s86, s47, 14
  buffer_load_dwordx4 v[24:27], v12, s[28:31], s86 offen sc1
  s_add_u32 s47, s47, 1
  buffer_load_dwordx4 v[28:31], v12, s[28:31], s86 offen offset:1024 sc1
  s_cmp_eq_u32 s47, 22
  s_cselect_b32 s47, 0, s47
  s_waitcnt vmcnt(24) lgkmcnt(0)
  v_mfma_f32_32x32x16_bf16 v[96:111], v[32:35], v[80:83], v[96:111]
  ds_read_b64_tr_b16 v[88:89], v234 offset:14336
  ds_read_b64_tr_b16 v[90:91], v234 offset:15360
  v_mfma_f32_32x32x16_bf16 v[112:127], v[36:39], v[80:83], v[112:127]
  ds_read_b64_tr_b16 v[92:93], v235 offset:14336
  ds_read_b64_tr_b16 v[94:95], v235 offset:15360
  v_mfma_f32_32x32x16_bf16 v[128:143], v[32:35], v[84:87], v[128:143]
  s_lshl_b32 s87, s44, 14
  s_add_u32 m0, s77, 12288
  s_add_u32 s44, s44, 1
  buffer_load_dwordx4 v244, s[24:27], s87 offen lds
  s_add_u32 m0, s77, 13312
  s_and_b32 s44, s44, 7
  buffer_load_dwordx4 v245, s[24:27], s87 offen lds
  v_mfma_f32_32x32x16_bf16 v[144:159], v[36:39], v[84:87], v[144:159]
  s_lshl_b32 s86, s47, 14
  buffer_load_dwordx4 v[32:35], v12, s[28:31], s86 offen sc1
  s_add_u32 s47, s47, 1
  buffer_load_dwordx4 v[36:39], v12, s[28:31], s86 offen offset:1024 sc1
  s_cmp_eq_u32 s47, 22
  s_cselect_b32 s47, 0, s47
  s_waitcnt vmcnt(24) lgkmcnt(0)
  v_mfma_f32_32x32x16_bf16 v[96:111], v[40:43], v[88:91], v[96:111]
  ds_read_b64_tr_b16 v[80:81], v246 offset:0
  ds_read_b64_tr_b16 v[82:83], v246 offset:1024
  v_mfma_f32_32x32x16_bf16 v[112:127], v[44:47], v[88:91], v[112:127]
  ds_read_b64_tr_b16 v[84:85], v247 offset:0
  ds_read_b64_tr_b16 v[86:87], v247 offset:1024
  v_mfma_f32_32x32x16_bf16 v[128:143], v[40:43], v[92:95], v[128:143]
  s_lshl_b32 s87, s44, 14
  s_add_u32 m0, s77, 14336
  s_add_u32 s44, s44, 1
  buffer_load_dwordx4 v244, s[24:27], s87 offen lds
  s_add_u32 m0, s77, 15360
  s_and_b32 s44, s44, 7
  buffer_load_dwordx4 v245, s[24:27], s87 offen lds
  v_mfma_f32_32x32x16_bf16 v[144:159], v[44:47], v[92:95], v[144:159]
  s_lshl_b32 s86, s47, 14
  buffer_load_dwordx4 v[40:43], v12, s[28:31], s86 offen sc1
  s_add_u32 s47, s47, 1
  buffer_load_dwordx4 v[44:47], v12, s[28:31], s86 offen offset:1024 sc1
  s_cmp_eq_u32 s47, 22
  s_cselect_b32 s47, 0, s47
  s_waitcnt vmcnt(24) lgkmcnt(0)
  v_mfma_f32_32x32x16_bf16 v[96:111], v[48:51], v[80:83], v[96:111]
  ds_read_b64_tr_b16 v[88:89], v246 offset:2048
  ds_read_b64_tr_b16 v[90:91], v246 offset:3072
  v_mfma_f32_32x32x16_bf16 v[112:127], v[52:55], v[80:83], v[112:127]
  ds_read_b64_tr_b16 v[92:93], v247 offset:2048
  ds_read_b64_tr_b16 v[94:95], v247 offset:3072
  v_mfma_f32_32x32x16_bf16 v[128:143], v[48:51], v[84:87], v[128:143]
  s_lshl_b32 s87, s44, 14
  s_add_u32 m0, s74, 0
  s_add_u32 s44, s44, 1
  buffer_load_dwordx4 v244, s[24:27], s87 offen lds
  s_add_u32 m0, s74, 1024
  s_and_b32 s44, s44, 7
  buffer_load_dwordx4 v245, s[24:27], s87 offen lds
  v_mfma_f32_32x32x16_bf16 v[144:159], v[52:55], v[84:87], v[144:159]
  s_lshl_b32 s86, s47, 14
  buffer_load_dwordx4 v[48:51], v12, s[28:31], s86 offen sc1
  s_add_u32 s47, s47, 1
  buffer_load_dwordx4 v[52:55], v12, s[28:31], s86 offen offset:1024 sc1
  s_cmp_eq_u32 s47, 22
  s_cselect_b32 s47, 0, s47
  s_waitcnt vmcnt(24) lgkmcnt(0)
  v_mfma_f32_32x32x16_bf16 v[96:111], v[56:59], v[88:91], v[96:111]
  ds_read_b64_tr_b16 v[80:81], v246 offset:4096
  v_mfma_f32_32x32x16_bf16 v[112:127], v[60:63], v[88:91], v[112:127]
  ds_read_b64_tr_b16 v[82:83], v246 offset:5120
  v_mfma_f32_32x32x16_bf16 v[128:143], v[56:59], v[92:95], v[128:143]
  ds_read_b64_tr_b16 v[84:85], v247 offset:4096
  v_mfma_f32_32x32x16_bf16 v[144:159], v[60:63], v[92:95], v[144:159]
  ds_read_b64_tr_b16 v[86:87], v247 offset:5120
  s_lshl_b32 s86, s47, 14
  buffer_load_dwordx4 v[56:59], v12, s[28:31], s86 offen sc1
  s_add_u32 s47, s47, 1
  buffer_load_dwordx4 v[60:63], v12, s[28:31], s86 offen offset:1024 sc1
  s_cmp_eq_u32 s47, 22
  s_cselect_b32 s47, 0, s47
  s_waitcnt vmcnt(22) lgkmcnt(0)
  v_mfma_f32_32x32x16_bf16 v[96:111], v[64:67], v[80:83], v[96:111]
  ds_read_b64_tr_b16 v[88:89], v246 offset:6144
  v_mfma_f32_32x32x16_bf16 v[112:127], v[68:71], v[80:83], v[112:127]
  ds_read_b64_tr_b16 v[90:91], v246 offset:7168
  v_mfma_f32_32x32x16_bf16 v[128:143], v[64:67], v[84:87], v[128:143]
  ds_read_b64_tr_b16 v[92:93], v247 offset:6144
  v_mfma_f32_32x32x16_bf16 v[144:159], v[68:71], v[84:87], v[144:159]
  ds_read_b64_tr_b16 v[94:95], v247 offset:7168
  buffer_load_dwordx2 v[10:11], v8, s[12:15], 0 offen sc1
  s_waitcnt vmcnt(19) lgkmcnt(0)
  v_mfma_f32_32x32x16_bf16 v[96:111], v[72:75], v[88:91], v[96:111]
  ds_read_b64_tr_b16 v[80:81], v246 offset:8192
  v_mfma_f32_32x32x16_bf16 v[112:127], v[76:79], v[88:91], v[112:127]
  ds_read_b64_tr_b16 v[82:83], v246 offset:9216
  v_mfma_f32_32x32x16_bf16 v[128:143], v[72:75], v[92:95], v[128:143]
  ds_read_b64_tr_b16 v[84:85], v247 offset:8192
  v_mfma_f32_32x32x16_bf16 v[144:159], v[76:79], v[92:95], v[144:159]
  ds_read_b64_tr_b16 v[86:87], v247 offset:9216
  s_waitcnt vmcnt(15) lgkmcnt(0)
  v_mfma_f32_32x32x16_bf16 v[96:111], v[16:19], v[80:83], v[96:111]
  ds_read_b64_tr_b16 v[88:89], v232 offset:0
  v_mfma_f32_32x32x16_bf16 v[112:127], v[20:23], v[80:83], v[112:127]
  ds_read_b64_tr_b16 v[90:91], v232 offset:1024
  v_mfma_f32_32x32x16_bf16 v[128:143], v[16:19], v[84:87], v[128:143]
  ds_read_b64_tr_b16 v[92:93], v233 offset:0
  v_mfma_f32_32x32x16_bf16 v[144:159], v[20:23], v[84:87], v[144:159]
  ds_read_b64_tr_b16 v[94:95], v233 offset:1024
  s_waitcnt vmcnt(11) lgkmcnt(0)
  v_mfma_f32_32x32x16_bf16 v[96:111], v[24:27], v[88:91], v[96:111]
  ds_read_b64_tr_b16 v[80:81], v232 offset:2048
  v_mfma_f32_32x32x16_bf16 v[112:127], v[28:31], v[88:91], v[112:127]
  ds_read_b64_tr_b16 v[82:83], v232 offset:3072
  v_mfma_f32_32x32x16_bf16 v[128:143], v[24:27], v[92:95], v[128:143]
  ds_read_b64_tr_b16 v[84:85], v233 offset:2048
  v_mfma_f32_32x32x16_bf16 v[144:159], v[28:31], v[92:95], v[144:159]
  ds_read_b64_tr_b16 v[86:87], v233 offset:3072
  s_waitcnt vmcnt(7) lgkmcnt(0)
  v_mfma_f32_32x32x16_bf16 v[96:111], v[32:35], v[80:83], v[96:111]
  ds_read_b64_tr_b16 v[88:89], v232 offset:4096
  v_mfma_f32_32x32x16_bf16 v[112:127], v[36:39], v[80:83], v[112:127]
  ds_read_b64_tr_b16 v[90:91], v232 offset:5120
  v_mfma_f32_32x32x16_bf16 v[128:143], v[32:35], v[84:87], v[128:143]
  ds_read_b64_tr_b16 v[92:93], v233 offset:4096
  v_mfma_f32_32x32x16_bf16 v[144:159], v[36:39], v[84:87], v[144:159]
  ds_read_b64_tr_b16 v[94:95], v233 offset:5120
  s_waitcnt vmcnt(0)
  s_mov_b32 s97, 0
  v_cmp_eq_u64 vcc, s[68:69], v[10:11]
  s_cmp_eq_u64 vcc, exec
  s_cbranch_scc1 L_fld_29
  s_andn2_b64 s[94:95], exec, vcc
  s_ff1_i32_b64 s96, s[94:95]
  s_lshl_b64 s[94:95], 1, s96
  s_mov_b64 exec, s[94:95]
L_fl1_27:
  s_sleep 1
  buffer_load_dwordx2 v[10:11], v8, s[12:15], 0 offen sc1
  s_add_u32 s97, s97, 1
  s_waitcnt vmcnt(0)
  v_cmp_eq_u64 vcc, s[68:69], v[10:11]
  s_cmp_eq_u64 vcc, exec
  s_cbranch_scc1 L_fl2_28
  s_cmp_gt_u32 s97, 60000
  s_cbranch_scc0 L_fl1_27
L_fl2_28:
  s_mov_b64 exec, -1
L_fl_26:
  v_cmp_eq_u64 vcc, s[68:69], v[10:11]
  s_cmp_eq_u64 vcc, exec
  s_cbranch_scc1 L_fld_29
  s_add_u32 s97, s97, 1
  s_cmp_gt_u32 s97, 60000
  s_cbranch_scc1 L_fld_29
  s_andn2_b64 exec, exec, vcc
  buffer_load_dwordx2 v[10:11], v8, s[12:15], 0 offen sc1
  s_mov_b64 exec, -1
  s_waitcnt vmcnt(0)
  s_branch L_fl_26
L_fld_29:
  s_lshl_b32 s86, s45, 10
  buffer_load_dwordx4 v[64:67], v13, s[12:15], s86 offen sc1
  s_add_u32 s45, s45, 1
  buffer_load_dwordx4 v[68:71], v14, s[12:15], s86 offen sc1
  s_and_b32 s45, s45, 7
  s_lshl_b32 s86, s45, 10
  buffer_load_dwordx4 v[72:75], v13, s[12:15], s86 offen sc1
  s_add_u32 s45, s45, 1
  buffer_load_dwordx4 v[76:79], v14, s[12:15], s86 offen sc1
  s_and_b32 s45, s45, 7
  s_lshl_b32 s86, s45, 10
  buffer_load_dwordx4 v[16:19], v13, s[12:15], s86 offen sc1
  s_add_u32 s45, s45, 1
  buffer_load_dwordx4 v[20:23], v14, s[12:15], s86 offen sc1
  s_and_b32 s45, s45, 7
  s_lshl_b32 s86, s45, 10
  buffer_load_dwordx4 v[24:27], v13, s[12:15], s86 offen sc1
  s_add_u32 s45, s45, 1
  buffer_load_dwordx4 v[28:31], v14, s[12:15], s86 offen sc1
  s_and_b32 s45, s45, 7
  s_lshl_b32 s86, s45, 10
  buffer_load_dwordx4 v[32:35], v13, s[12:15], s86 offen sc1
  s_add_u32 s45, s45, 1
  buffer_load_dwordx4 v[36:39], v14, s[12:15], s86 offen sc1
  s_and_b32 s45, s45, 7
  s_waitcnt lgkmcnt(0)
  v_mfma_f32_32x32x16_bf16 v[96:111], v[40:43], v[88:91], v[96:111]
  ds_read_b64_tr_b16 v[80:81], v232 offset:6144
  v_mfma_f32_32x32x16_bf16 v[112:127], v[44:47], v[88:91], v[112:127]
  ds_read_b64_tr_b16 v[82:83], v232 offset:7168
  v_mfma_f32_32x32x16_bf16 v[128:143], v[40:43], v[92:95], v[128:143]
  ds_read_b64_tr_b16 v[84:85], v233 offset:6144
  v_mfma_f32_32x32x16_bf16 v[144:159], v[44:47], v[92:95], v[144:159]
  ds_read_b64_tr_b16 v[86:87], v233 offset:7168
  s_lshl_b32 s86, s45, 10
  buffer_load_dwordx4 v[40:43], v13, s[12:15], s86 offen sc1
  s_add_u32 s45, s45, 1
  buffer_load_dwordx4 v[44:47], v14, s[12:15], s86 offen sc1
  s_and_b32 s45, s45, 7
  s_waitcnt lgkmcnt(0)
  v_mfma_f32_32x32x16_bf16 v[96:111], v[48:51], v[80:83], v[96:111]
  ds_read_b64_tr_b16 v[88:89], v234 offset:0
  v_mfma_f32_32x32x16_bf16 v[112:127], v[52:55], v[80:83], v[112:127]
  ds_read_b64_tr_b16 v[90:91], v234 offset:1024
  v_mfma_f32_32x32x16_bf16 v[128:143], v[48:51], v[84:87], v[128:143]
  ds_read_b64_tr_b16 v[92:93], v235 offset:0
  v_mfma_f32_32x32x16_bf16 v[144:159], v[52:55], v[84:87], v[144:159]
  ds_read_b64_tr_b16 v[94:95], v235 offset:1024
  s_lshl_b32 s86, s45, 10
  buffer_load_dwordx4 v[48:51], v13, s[12:15], s86 offen sc1
  s_add_u32 s45, s45, 1
  buffer_load_dwordx4 v[52:55], v14, s[12:15], s86 offen sc1
  s_and_b32 s45, s45, 7
  s_waitcnt vmcnt(12) lgkmcnt(0)
  v_mfma_f32_32x32x16_bf16 v[96:111], v[56:59], v[88:91], v[96:111]
  ds_read_b64_tr_b16 v[80:81], v234 offset:2048
  v_mfma_f32_32x32x16_bf16 v[112:127], v[60:63], v[88:91], v[112:127]
  ds_read_b64_tr_b16 v[82:83], v234 offset:3072
  v_mfma_f32_32x32x16_bf16 v[128:143], v[56:59], v[92:95], v[128:143]
  ds_read_b64_tr_b16 v[84:85], v235 offset:2048
  v_mfma_f32_32x32x16_bf16 v[144:159], v[60:63], v[92:95], v[144:159]
  ds_read_b64_tr_b16 v[86:87], v235 offset:3072
  s_lshl_b32 s86, s45, 10
  buffer_load_dwordx4 v[56:59], v13, s[12:15], s86 offen sc1
  s_add_u32 s45, s45, 1
  buffer_load_dwordx4 v[60:63], v14, s[12:15], s86 offen sc1
  s_and_b32 s45, s45, 7
  s_waitcnt vmcnt(12) lgkmcnt(0)
  s_nop 7
  s_nop 7
  v_sub_f32 v228, 1.0, v224
  v_sub_f32 v229, 1.0, v225
  v_mul_f32 v96, v96, v228
  v_mul_f32 v97, v97, v228
  v_mul_f32 v98, v98, v228
  v_mul_f32 v99, v99, v228
  v_mul_f32 v100, v100, v228
  v_mul_f32 v101, v101, v228
  v_mul_f32 v102, v102, v228
  v_mul_f32 v103, v103, v228
  v_mul_f32 v104, v104, v228
  v_mul_f32 v105, v105, v228
  v_mul_f32 v106, v106, v228
  v_mul_f32 v107, v107, v228
  v_mul_f32 v108, v108, v228
  v_mul_f32 v109, v109, v228
  v_mul_f32 v110, v110, v228
  v_mul_f32 v111, v111, v228
  v_mul_f32 v112, v112, v228
  v_mul_f32 v113, v113, v228
  v_mul_f32 v114, v114, v228
  v_mul_f32 v115, v115, v228
  v_mul_f32 v116, v116, v228
  v_mul_f32 v117, v117, v228
  v_mul_f32 v118, v118, v228
  v_mul_f32 v119, v119, v228
  v_mul_f32 v120, v120, v228
  v_mul_f32 v121, v121, v228
  v_mul_f32 v122, v122, v228
  v_mul_f32 v123, v123, v228
  v_mul_f32 v124, v124, v228
  v_mul_f32 v125, v125, v228
  v_mul_f32 v126, v126, v228
  v_mul_f32 v127, v127, v228
  v_mul_f32 v128, v128, v229
  v_mul_f32 v129, v129, v229
  v_mul_f32 v130, v130, v229
  v_mul_f32 v131, v131, v229
  v_mul_f32 v132, v132, v229
  v_mul_f32 v133, v133, v229
  v_mul_f32 v134, v134, v229
  v_mul_f32 v135, v135, v229
  v_mul_f32 v136, v136, v229
  v_mul_f32 v137, v137, v229
  v_mul_f32 v138, v138, v229
  v_mul_f32 v139, v139, v229
  v_mul_f32 v140, v140, v229
  v_mul_f32 v141, v141, v229
  v_mul_f32 v142, v142, v229
  v_mul_f32 v143, v143, v229
  v_mul_f32 v144, v144, v229
  v_mul_f32 v145, v145, v229
  v_mul_f32 v146, v146, v229
  v_mul_f32 v147, v147, v229
  v_mul_f32 v148, v148, v229
  v_mul_f32 v149, v149, v229
  v_mul_f32 v150, v150, v229
  v_mul_f32 v151, v151, v229
  v_mul_f32 v152, v152, v229
  v_mul_f32 v153, v153, v229
  v_mul_f32 v154, v154, v229
  v_mul_f32 v155, v155, v229
  v_mul_f32 v156, v156, v229
  v_mul_f32 v157, v157, v229
  v_mul_f32 v158, v158, v229
  v_mul_f32 v159, v159, v229
  s_nop 1
  v_mfma_f32_32x32x16_bf16 v[96:111], v[80:83], v[64:67], v[96:111]
  ds_read_b64_tr_b16 v[88:89], v234 offset:4096
  v_mfma_f32_32x32x16_bf16 v[112:127], v[84:87], v[64:67], v[112:127]
  ds_read_b64_tr_b16 v[90:91], v234 offset:5120
  v_mfma_f32_32x32x16_bf16 v[128:143], v[80:83], v[68:71], v[128:143]
  ds_read_b64_tr_b16 v[92:93], v235 offset:4096
  v_mfma_f32_32x32x16_bf16 v[144:159], v[84:87], v[68:71], v[144:159]
  ds_read_b64_tr_b16 v[94:95], v235 offset:5120
  s_waitcnt vmcnt(10) lgkmcnt(0)
  v_mfma_f32_32x32x16_bf16 v[96:111], v[88:91], v[72:75], v[96:111]
  ds_read_b64_tr_b16 v[80:81], v234 offset:6144
  v_mfma_f32_32x32x16_bf16 v[112:127], v[92:95], v[72:75], v[112:127]
  ds_read_b64_tr_b16 v[82:83], v234 offset:7168
  v_mfma_f32_32x32x16_bf16 v[128:143], v[88:91], v[76:79], v[128:143]
  ds_read_b64_tr_b16 v[84:85], v235 offset:6144
  v_mfma_f32_32x32x16_bf16 v[144:159], v[92:95], v[76:79], v[144:159]
  ds_read_b64_tr_b16 v[86:87], v235 offset:7168
  s_waitcnt vmcnt(8) lgkmcnt(0)
  v_mfma_f32_32x32x16_bf16 v[96:111], v[80:83], v[16:19], v[96:111]
  ds_read_b64_tr_b16 v[88:89], v234 offset:8192
  v_mfma_f32_32x32x16_bf16 v[112:127], v[84:87], v[16:19], v[112:127]
  ds_read_b64_tr_b16 v[90:91], v234 offset:9216
  v_mfma_f32_32x32x16_bf16 v[128:143], v[80:83], v[20:23], v[128:143]
  ds_read_b64_tr_b16 v[92:93], v235 offset:8192
  v_mfma_f32_32x32x16_bf16 v[144:159], v[84:87], v[20:23], v[144:159]
  ds_read_b64_tr_b16 v[94:95], v235 offset:9216
  s_waitcnt vmcnt(6) lgkmcnt(0)
  v_mfma_f32_32x32x16_bf16 v[96:111], v[88:91], v[24:27], v[96:111]
  ds_read_b64_tr_b16 v[80:81], v234 offset:10240
  v_mfma_f32_32x32x16_bf16 v[112:127], v[92:95], v[24:27], v[112:127]
  ds_read_b64_tr_b16 v[82:83], v234 offset:11264
  v_mfma_f32_32x32x16_bf16 v[128:143], v[88:91], v[28:31], v[128:143]
  ds_read_b64_tr_b16 v[84:85], v235 offset:10240
  v_mfma_f32_32x32x16_bf16 v[144:159], v[92:95], v[28:31], v[144:159]
  ds_read_b64_tr_b16 v[86:87], v235 offset:11264
  s_waitcnt vmcnt(4) lgkmcnt(0)
  v_mfma_f32_32x32x16_bf16 v[96:111], v[80:83], v[32:35], v[96:111]
  ds_read_b64_tr_b16 v[88:89], v234 offset:12288
  v_mfma_f32_32x32x16_bf16 v[112:127], v[84:87], v[32:35], v[112:127]
  ds_read_b64_tr_b16 v[90:91], v234 offset:13312
  v_mfma_f32_32x32x16_bf16 v[128:143], v[80:83], v[36:39], v[128:143]
  ds_read_b64_tr_b16 v[92:93], v235 offset:12288
  v_mfma_f32_32x32x16_bf16 v[144:159], v[84:87], v[36:39], v[144:159]
  ds_read_b64_tr_b16 v[94:95], v235 offset:13312
  s_waitcnt vmcnt(2) lgkmcnt(0)
  v_mfma_f32_32x32x16_bf16 v[96:111], v[88:91], v[40:43], v[96:111]
  ds_read_b64_tr_b16 v[80:81], v234 offset:14336
  v_mfma_f32_32x32x16_bf16 v[112:127], v[92:95], v[40:43], v[112:127]
  ds_read_b64_tr_b16 v[82:83], v234 offset:15360
  v_mfma_f32_32x32x16_bf16 v[128:143], v[88:91], v[44:47], v[128:143]
  ds_read_b64_tr_b16 v[84:85], v235 offset:14336
  v_mfma_f32_32x32x16_bf16 v[144:159], v[92:95], v[44:47], v[144:159]
  ds_read_b64_tr_b16 v[86:87], v235 offset:15360
  s_waitcnt vmcnt(0) lgkmcnt(0)
  v_mfma_f32_32x32x16_bf16 v[96:111], v[80:83], v[48:51], v[96:111]
  ds_read_b64_tr_b16 v[88:89], v246 offset:0
  v_mfma_f32_32x32x16_bf16 v[112:127], v[84:87], v[48:51], v[112:127]
  ds_read_b64_tr_b16 v[90:91], v246 offset:1024
  v_mfma_f32_32x32x16_bf16 v[128:143], v[80:83], v[52:55], v[128:143]
  ds_read_b64_tr_b16 v[92:93], v247 offset:0
  v_mfma_f32_32x32x16_bf16 v[144:159], v[84:87], v[52:55], v[144:159]
  ds_read_b64_tr_b16 v[94:95], v247 offset:1024
  s_waitcnt lgkmcnt(0)
  v_mfma_f32_32x32x16_bf16 v[96:111], v[88:91], v[56:59], v[96:111]
  v_mfma_f32_32x32x16_bf16 v[112:127], v[92:95], v[56:59], v[112:127]
  v_mfma_f32_32x32x16_bf16 v[128:143], v[88:91], v[60:63], v[128:143]
  v_mfma_f32_32x32x16_bf16 v[144:159], v[92:95], v[60:63], v[144:159]
  v_add_u32 v8, s77, v250
  s_lshl_b32 s83, s3, 12
  s_add_u32 s83, s83, 40960
  v_add_u32 v9, s83, v250
  s_nop 7
  s_nop 7
  ds_write_b128 v8, v[96:99] offset:0
  ds_write_b128 v8, v[100:103] offset:1024
  ds_write_b128 v8, v[104:107] offset:2048
  ds_write_b128 v8, v[108:111] offset:3072
  ds_write_b128 v8, v[112:115] offset:4096
  ds_write_b128 v8, v[116:119] offset:5120
  ds_write_b128 v8, v[120:123] offset:6144
  ds_write_b128 v8, v[124:127] offset:7168
  ds_write_b128 v8, v[128:131] offset:8192
  ds_write_b128 v8, v[132:135] offset:9216
  ds_write_b128 v8, v[136:139] offset:10240
  ds_write_b128 v8, v[140:143] offset:11264
  ds_write_b128 v8, v[144:147] offset:12288
  ds_write_b128 v8, v[148:151] offset:13312
  ds_write_b128 v8, v[152:155] offset:14336
  ds_write_b128 v8, v[156:159] offset:15360
  s_waitcnt lgkmcnt(0)
  v_mov_b32 v10, 1
  s_mov_b64 exec, 1
  ds_add_u32 v251, v10 offset:4
  s_mov_b64 exec, -1
  s_mov_b32 s97, 0
L_lb_30:
  ds_read_b32 v11, v251 offset:4
  s_waitcnt lgkmcnt(0)
  v_readfirstlane_b32 s96, v11
  s_add_u32 s97, s97, 1
  s_cmp_ge_u32 s96, 4
  s_cbranch_scc1 L_lbd_31
  s_cmp_gt_u32 s97, 240000
  s_cbranch_scc1 L_lbd_31
  s_branch L_lb_30
L_lbd_31:
  ds_read_b128 v[16:19], v9 offset:0
  ds_read_b128 v[20:23], v9 offset:1024
  ds_read_b128 v[24:27], v9 offset:2048
  ds_read_b128 v[28:31], v9 offset:3072
  ds_read_b128 v[32:35], v9 offset:16384
  ds_read_b128 v[36:39], v9 offset:17408
  ds_read_b128 v[40:43], v9 offset:18432
  ds_read_b128 v[44:47], v9 offset:19456
  ds_read_b128 v[48:51], v9 offset:32768
  ds_read_b128 v[52:55], v9 offset:33792
  ds_read_b128 v[56:59], v9 offset:34816
  ds_read_b128 v[60:63], v9 offset:35840
  ds_read_b128 v[64:67], v9 offset:49152
  ds_read_b128 v[68:71], v9 offset:50176
  ds_read_b128 v[72:75], v9 offset:51200
  ds_read_b128 v[76:79], v9 offset:52224
  s_lshr_b32 s83, s3, 1
  s_cmp_eq_u32 s83, 0
  s_cselect_b64 vcc, -1, 0
  v_cndmask_b32 v10, v229, v228, vcc
  v_cndmask_b32 v11, v227, v226, vcc
  v_lshlrev_b32 v11, 16, v11
  v_mul_f32 v10, v10, v11
  s_lshl_b32 s84, s83, 5
  v_add_u32 v7, s84, v7
  v_lshlrev_b32 v7, 10, v7
  s_lshl_b32 s84, s73, 7
  s_and_b32 s85, s3, 1
  s_lshl_b32 s85, s85, 6
  s_add_u32 s84, s84, s85
  v_add_u32 v7, s84, v7
  v_lshrrev_b32 v8, 5, v2
  v_lshl_add_u32 v7, v8, 4, v7
  s_waitcnt lgkmcnt(0)
  v_add_f32 v16, v16, v32
  v_add_f32 v48, v48, v64
  v_add_f32 v16, v16, v10
  v_add_f32 v16, v16, v48
  v_add_f32 v17, v17, v33
  v_add_f32 v49, v49, v65
  v_add_f32 v17, v17, v10
  v_add_f32 v17, v17, v49
  v_add_f32 v18, v18, v34
  v_add_f32 v50, v50, v66
  v_add_f32 v18, v18, v10
  v_add_f32 v18, v18, v50
  v_add_f32 v19, v19, v35
  v_add_f32 v51, v51, v67
  v_add_f32 v19, v19, v10
  v_add_f32 v19, v19, v51
  v_add_f32 v20, v20, v36
  v_add_f32 v52, v52, v68
  v_add_f32 v20, v20, v10
  v_add_f32 v20, v20, v52
  v_add_f32 v21, v21, v37
  v_add_f32 v53, v53, v69
  v_add_f32 v21, v21, v10
  v_add_f32 v21, v21, v53
  v_add_f32 v22, v22, v38
  v_add_f32 v54, v54, v70
  v_add_f32 v22, v22, v10
  v_add_f32 v22, v22, v54
  v_add_f32 v23, v23, v39
  v_add_f32 v55, v55, v71
  v_add_f32 v23, v23, v10
  v_add_f32 v23, v23, v55
  v_add_f32 v24, v24, v40
  v_add_f32 v56, v56, v72
  v_add_f32 v24, v24, v10
  v_add_f32 v24, v24, v56
  v_add_f32 v25, v25, v41
  v_add_f32 v57, v57, v73
  v_add_f32 v25, v25, v10
  v_add_f32 v25, v25, v57
  v_add_f32 v26, v26, v42
  v_add_f32 v58, v58, v74
  v_add_f32 v26, v26, v10
  v_add_f32 v26, v26, v58
  v_add_f32 v27, v27, v43
  v_add_f32 v59, v59, v75
  v_add_f32 v27, v27, v10
  v_add_f32 v27, v27, v59
  v_add_f32 v28, v28, v44
  v_add_f32 v60, v60, v76
  v_add_f32 v28, v28, v10
  v_add_f32 v28, v28, v60
  v_add_f32 v29, v29, v45
  v_add_f32 v61, v61, v77
  v_add_f32 v29, v29, v10
  v_add_f32 v29, v29, v61
  v_add_f32 v30, v30, v46
  v_add_f32 v62, v62, v78
  v_add_f32 v30, v30, v10
  v_add_f32 v30, v30, v62
  v_add_f32 v31, v31, v47
  v_add_f32 v63, v63, v79
  v_add_f32 v31, v31, v10
  v_add_f32 v31, v31, v63
  v_cvt_pk_bf16_f32 v32, v16, v17
  v_cvt_pk_bf16_f32 v33, v18, v19
  v_cvt_pk_bf16_f32 v34, v20, v21
  v_cvt_pk_bf16_f32 v35, v22, v23
  v_cvt_pk_bf16_f32 v36, v24, v25
  v_cvt_pk_bf16_f32 v37, v26, v27
  v_cvt_pk_bf16_f32 v38, v28, v29
  v_cvt_pk_bf16_f32 v39, v30, v31
  s_nop 1
  v_permlane32_swap_b32 v32, v34
  v_permlane32_swap_b32 v33, v35
  v_permlane32_swap_b32 v36, v38
  v_permlane32_swap_b32 v37, v39
  buffer_store_dwordx4 v[32:35], v7, s[32:35], 0 offen
  buffer_store_dwordx4 v[36:39], v7, s[32:35], 0 offen offset:32
  s_endpgm
L_attn:
  s_sub_u32 s3, s3, 4
  s_setprio 2
  s_or_b32 s83, s2, s3
  s_cmp_lg_u32 s83, 0
  s_cbranch_scc1 L_a_notok
  s_memrealtime s[70:71]
  s_waitcnt lgkmcnt(0)
  s_or_b32 s70, s70, 1
  v_mov_b32 v4, s70
  v_mov_b32 v5, s71
  s_mov_b64 exec, 1
  buffer_store_dwordx2 v[4:5], v252, s[64:67], 0 offen sc1
  s_mov_b64 exec, -1
L_a_notok:
  s_cmp_lt_u32 s2, 192
  s_cbranch_scc0 L_a_noqkv
  s_mov_b32 s4, s40
  s_and_b32 s5, s41, 0xffff
  s_mov_b32 s6, 0x200000
  s_mov_b32 s7, 0x00020000
  s_mov_b32 s8, s42
  s_and_b32 s9, s43, 0xffff
  s_mov_b32 s10, 0x180000
  s_mov_b32 s11, 0x00020000
  s_and_b32 s83, s81, 3
  s_lshl_b32 s83, s83, 2
  s_and_b32 s84, s82, 3
  s_add_u32 s36, s83, s84
  s_lshr_b32 s83, s81, 2
  s_mul_i32 s83, s83, 6
  s_lshr_b32 s84, s82, 2
  s_add_u32 s37, s83, s84
  s_lshl_b32 s38, s3, 12
  s_add_u32 s38, s38, 40960
  v_lshrrev_b32 v3, 3, v2
  v_and_b32 v12, 7, v2
  s_lshl_b32 s83, s36, 17
  s_lshl_b32 s84, s3, 5
  s_add_u32 s84, s84, 0
  v_add_u32 v13, s84, v3
  v_lshrrev_b32 v14, 1, v13
  v_and_b32 v14, 7, v14
  v_xor_b32 v14, v14, v12
  v_lshlrev_b32 v14, 4, v14
  v_lshl_add_u32 v14, v13, 10, v14
  v_add_u32 v4, s83, v14
  s_lshl_b32 s84, s3, 5
  s_add_u32 s84, s84, 8
  v_add_u32 v13, s84, v3
  v_lshrrev_b32 v14, 1, v13
  v_and_b32 v14, 7, v14
  v_xor_b32 v14, v14, v12
  v_lshlrev_b32 v14, 4, v14
  v_lshl_add_u32 v14, v13, 10, v14
  v_add_u32 v5, s83, v14
  s_lshl_b32 s84, s3, 5
  s_add_u32 s84, s84, 16
  v_add_u32 v13, s84, v3
  v_lshrrev_b32 v14, 1, v13
  v_and_b32 v14, 7, v14
  v_xor_b32 v14, v14, v12
  v_lshlrev_b32 v14, 4, v14
  v_lshl_add_u32 v14, v13, 10, v14
  v_add_u32 v6, s83, v14
  s_lshl_b32 s84, s3, 5
  s_add_u32 s84, s84, 24
  v_add_u32 v13, s84, v3
  v_lshrrev_b32 v14, 1, v13
  v_and_b32 v14, 7, v14
  v_xor_b32 v14, v14, v12
  v_lshlrev_b32 v14, 4, v14
  v_lshl_add_u32 v14, v13, 10, v14
  v_add_u32 v7, s83, v14
  v_lshrrev_b32 v3, 4, v2
  v_and_b32 v12, 15, v2
  v_lshrrev_b32 v13, 2, v12
  v_xor_b32 v13, v13, v3
  v_lshlrev_b32 v13, 2, v13
  v_and_b32 v12, 3, v12
  v_or_b32 v13, v13, v12
  v_lshlrev_b32 v13, 4, v13
  s_lshl_b32 s83, s37, 8
  v_add_u32 v13, s83, v13
  s_movk_i32 s85, 3072
  s_lshl_b32 s84, s3, 4
  s_add_u32 s84, s84, 0
  v_add_u32 v14, s84, v3
  v_mul_lo_u32 v14, v14, s85
  v_add_u32 v8, v14, v13
  s_lshl_b32 s84, s3, 4
  s_add_u32 s84, s84, 4
  v_add_u32 v14, s84, v3
  v_mul_lo_u32 v14, v14, s85
  v_add_u32 v9, v14, v13
  s_lshl_b32 s84, s3, 4
  s_add_u32 s84, s84, 8
  v_add_u32 v14, s84, v3
  v_mul_lo_u32 v14, v14, s85
  v_add_u32 v10, v14, v13
  s_lshl_b32 s84, s3, 4
  s_add_u32 s84, s84, 12
  v_add_u32 v14, s84, v3
  v_mul_lo_u32 v14, v14, s85
  v_add_u32 v11, v14, v13
  s_and_b32 s39, s82, 7
  s_mov_b32 s16, 0
  s_mul_i32 s87, s39, 196608
  s_lshl_b32 s86, s39, 7
  s_add_u32 s17, s38, s16
  s_add_u32 m0, s17, 0
  s_nop 0
  buffer_load_dwordx4 v4, s[4:7], s86 offen lds
  s_add_u32 m0, s17, 16384
  s_nop 0
  buffer_load_dwordx4 v8, s[8:11], s87 offen lds
  s_add_u32 m0, s17, 1024
  s_nop 0
  buffer_load_dwordx4 v5, s[4:7], s86 offen lds
  s_add_u32 m0, s17, 17408
  s_nop 0
  buffer_load_dwordx4 v9, s[8:11], s87 offen lds
  s_add_u32 m0, s17, 2048
  s_nop 0
  buffer_load_dwordx4 v6, s[4:7], s86 offen lds
  s_add_u32 m0, s17, 18432
  s_nop 0
  buffer_load_dwordx4 v10, s[8:11], s87 offen lds
  s_add_u32 m0, s17, 3072
  s_nop 0
  buffer_load_dwordx4 v7, s[4:7], s86 offen lds
  s_add_u32 m0, s17, 19456
  s_nop 0
  buffer_load_dwordx4 v11, s[8:11], s87 offen lds
  s_add_u32 s39, s39, 1
  s_and_b32 s39, s39, 7
  s_add_u32 s16, s16, 32768
  s_cmp_eq_u32 s16, 98304
  s_cselect_b32 s16, 0, s16
  s_mul_i32 s87, s39, 196608
  s_lshl_b32 s86, s39, 7
  s_add_u32 s17, s38, s16
  s_add_u32 m0, s17, 0
  s_nop 0
  buffer_load_dwordx4 v4, s[4:7], s86 offen lds
  s_add_u32 m0, s17, 16384
  s_nop 0
  buffer_load_dwordx4 v8, s[8:11], s87 offen lds
  s_add_u32 m0, s17, 1024
  s_nop 0
  buffer_load_dwordx4 v5, s[4:7], s86 offen lds
  s_add_u32 m0, s17, 17408
  s_nop 0
  buffer_load_dwordx4 v9, s[8:11], s87 offen lds
  s_add_u32 m0, s17, 2048
  s_nop 0
  buffer_load_dwordx4 v6, s[4:7], s86 offen lds
  s_add_u32 m0, s17, 18432
  s_nop 0
  buffer_load_dwordx4 v10, s[8:11], s87 offen lds
  s_add_u32 m0, s17, 3072
  s_nop 0
  buffer_load_dwordx4 v7, s[4:7], s86 offen lds
  s_add_u32 m0, s17, 19456
  s_nop 0
  buffer_load_dwordx4 v11, s[8:11], s87 offen lds
  s_add_u32 s39, s39, 1
  s_and_b32 s39, s39, 7
  s_add_u32 s16, s16, 32768
  s_cmp_eq_u32 s16, 98304
  s_cselect_b32 s16, 0, s16
  s_mul_i32 s87, s39, 196608
  s_lshl_b32 s86, s39, 7
  s_add_u32 s17, s38, s16
  s_add_u32 m0, s17, 0
  s_nop 0
  buffer_load_dwordx4 v4, s[4:7], s86 offen lds
  s_add_u32 m0, s17, 16384
  s_nop 0
  buffer_load_dwordx4 v8, s[8:11], s87 offen lds
  s_add_u32 m0, s17, 1024
  s_nop 0
  buffer_load_dwordx4 v5, s[4:7], s86 offen lds
  s_add_u32 m0, s17, 17408
  s_nop 0
  buffer_load_dwordx4 v9, s[8:11], s87 offen lds
  s_add_u32 m0, s17, 2048
  s_nop 0
  buffer_load_dwordx4 v6, s[4:7], s86 offen lds
  s_add_u32 m0, s17, 18432
  s_nop 0
  buffer_load_dwordx4 v10, s[8:11], s87 offen lds
  s_add_u32 m0, s17, 3072
  s_nop 0
  buffer_load_dwordx4 v7, s[4:7], s86 offen lds
  s_add_u32 m0, s17, 19456
  s_nop 0
  buffer_load_dwordx4 v11, s[8:11], s87 offen lds
  s_add_u32 s39, s39, 1
  s_and_b32 s39, s39, 7
  s_add_u32 s16, s16, 32768
  s_cmp_eq_u32 s16, 98304
  s_cselect_b32 s16, 0, s16
  buffer_load_dwordx2 v[28:29], v252, s[64:67], 0 offen sc1
  s_and_b32 s88, s3, 1
  s_lshr_b32 s89, s3, 1
  v_and_b32 v3, 31, v2
  v_lshrrev_b32 v12, 5, v2
  s_lshl_b32 s84, s88, 6
  v_add_u32 v13, s84, v3
  v_lshrrev_b32 v14, 1, v13
  v_and_b32 v14, 7, v14
  v_lshlrev_b32 v13, 7, v13
  v_add_u32 v13, 40960, v13
  v_or_b32 v15, 0, v12
  v_xor_b32 v15, v15, v14
  v_lshl_add_u32 v16, v15, 4, v13
  v_mov_b32 v22, v16
  v_or_b32 v15, 2, v12
  v_xor_b32 v15, v15, v14
  v_lshl_add_u32 v17, v15, 4, v13
  v_mov_b32 v23, v17
  v_or_b32 v15, 4, v12
  v_xor_b32 v15, v15, v14
  v_lshl_add_u32 v18, v15, 4, v13
  v_mov_b32 v24, v18
  v_or_b32 v15, 6, v12
  v_xor_b32 v15, v15, v14
  v_lshl_add_u32 v19, v15, 4, v13
  v_mov_b32 v25, v19
  v_and_b32 v3, 15, v2
  v_lshrrev_b32 v13, 2, v3
  v_lshlrev_b32 v14, 11, v12
  v_lshl_add_u32 v14, v13, 8, v14
  v_bfe_u32 v15, v2, 4, 1
  v_lshl_add_u32 v14, v15, 5, v14
  v_and_b32 v15, 3, v3
  v_lshl_add_u32 v14, v15, 3, v14
  v_add_u32 v14, 57344, v14
  s_lshl_b32 s84, s89, 1
  s_add_u32 s85, s84, 0
  v_xor_b32 v15, s85, v13
  v_lshl_add_u32 v20, v15, 6, v14
  v_mov_b32 v26, v20
  s_add_u32 s85, s84, 1
  v_xor_b32 v15, s85, v13
  v_lshl_add_u32 v21, v15, 6, v14
  v_mov_b32 v27, v21
  v_pk_mov_b32 v[96:97], v[252:253], v[252:253] op_sel:[0,0]
  v_pk_mov_b32 v[98:99], v[252:253], v[252:253] op_sel:[0,0]
  v_pk_mov_b32 v[100:101], v[252:253], v[252:253] op_sel:[0,0]
  v_pk_mov_b32 v[102:103], v[252:253], v[252:253] op_sel:[0,0]
  v_pk_mov_b32 v[104:105], v[252:253], v[252:253] op_sel:[0,0]
  v_pk_mov_b32 v[106:107], v[252:253], v[252:253] op_sel:[0,0]
  v_pk_mov_b32 v[108:109], v[252:253], v[252:253] op_sel:[0,0]
  v_pk_mov_b32 v[110:111], v[252:253], v[252:253] op_sel:[0,0]
  v_pk_mov_b32 v[112:113], v[252:253], v[252:253] op_sel:[0,0]
  v_pk_mov_b32 v[114:115], v[252:253], v[252:253] op_sel:[0,0]
  v_pk_mov_b32 v[116:117], v[252:253], v[252:253] op_sel:[0,0]
  v_pk_mov_b32 v[118:119], v[252:253], v[252:253] op_sel:[0,0]
  v_pk_mov_b32 v[120:121], v[252:253], v[252:253] op_sel:[0,0]
  v_pk_mov_b32 v[122:123], v[252:253], v[252:253] op_sel:[0,0]
  v_pk_mov_b32 v[124:125], v[252:253], v[252:253] op_sel:[0,0]
  v_pk_mov_b32 v[126:127], v[252:253], v[252:253] op_sel:[0,0]
  v_pk_mov_b32 v[128:129], v[252:253], v[252:253] op_sel:[0,0]
  v_pk_mov_b32 v[130:131], v[252:253], v[252:253] op_sel:[0,0]
  v_pk_mov_b32 v[132:133], v[252:253], v[252:253] op_sel:[0,0]
  v_pk_mov_b32 v[134:135], v[252:253], v[252:253] op_sel:[0,0]
  v_pk_mov_b32 v[136:137], v[252:253], v[252:253] op_sel:[0,0]
  v_pk_mov_b32 v[138:139], v[252:253], v[252:253] op_sel:[0,0]
  v_pk_mov_b32 v[140:141], v[252:253], v[252:253] op_sel:[0,0]
  v_pk_mov_b32 v[142:143], v[252:253], v[252:253] op_sel:[0,0]
  v_pk_mov_b32 v[144:145], v[252:253], v[252:253] op_sel:[0,0]
  v_pk_mov_b32 v[146:147], v[252:253], v[252:253] op_sel:[0,0]
  v_pk_mov_b32 v[148:149], v[252:253], v[252:253] op_sel:[0,0]
  v_pk_mov_b32 v[150:151], v[252:253], v[252:253] op_sel:[0,0]
  v_pk_mov_b32 v[152:153], v[252:253], v[252:253] op_sel:[0,0]
  v_pk_mov_b32 v[154:155], v[252:253], v[252:253] op_sel:[0,0]
  v_pk_mov_b32 v[156:157], v[252:253], v[252:253] op_sel:[0,0]
  v_pk_mov_b32 v[158:159], v[252:253], v[252:253] op_sel:[0,0]
  s_cmp_ge_u32 s37, 8
  s_cbranch_scc1 L_vpath
  s_waitcnt vmcnt(17)
  v_mov_b32 v30, 1
  s_mov_b64 exec, 1
  ds_add_u32 v251, v30 offset:16
  s_mov_b64 exec, -1
  s_mov_b32 s18, 4
  s_mov_b32 s97, 0
L_qp_36:
  ds_read_b32 v31, v251 offset:16
  s_waitcnt lgkmcnt(0)
  v_readfirstlane_b32 s96, v31
  s_add_u32 s97, s97, 1
  s_cmp_ge_u32 s96, s18
  s_cbranch_scc1 L_qpd_37
  s_cmp_gt_u32 s97, 240000
  s_cbranch_scc0 L_qp_36
L_qpd_37:
  ds_read_b128 v[32:35], v22 offset:0
  ds_read_b128 v[36:39], v22 offset:4096
  ds_read_b64_tr_b16 v[40:41], v26 offset:0
  ds_read_b64_tr_b16 v[42:43], v26 offset:1024
  ds_read_b64_tr_b16 v[44:45], v27 offset:0
  ds_read_b64_tr_b16 v[46:47], v27 offset:1024
  ds_read_b128 v[48:51], v23 offset:0
  ds_read_b128 v[52:55], v23 offset:4096
  ds_read_b64_tr_b16 v[56:57], v26 offset:4096
  ds_read_b64_tr_b16 v[58:59], v26 offset:5120
  ds_read_b64_tr_b16 v[60:61], v27 offset:4096
  ds_read_b64_tr_b16 v[62:63], v27 offset:5120
  s_mov_b32 s90, 0
  s_mov_b32 s19, 0
L_qkv_32:
  s_waitcnt lgkmcnt(6)
  v_mfma_f32_32x32x16_bf16 v[96:111], v[40:43], v[32:35], v[96:111]
  ds_read_b128 v[64:67], v24 offset:0
  ds_read_b128 v[68:71], v24 offset:4096
  v_mfma_f32_32x32x16_bf16 v[112:127], v[40:43], v[36:39], v[112:127]
  ds_read_b64_tr_b16 v[72:73], v26 offset:8192
  ds_read_b64_tr_b16 v[74:75], v26 offset:9216
  v_mfma_f32_32x32x16_bf16 v[128:143], v[44:47], v[32:35], v[128:143]
  ds_read_b64_tr_b16 v[76:77], v27 offset:8192
  ds_read_b64_tr_b16 v[78:79], v27 offset:9216
  v_mfma_f32_32x32x16_bf16 v[144:159], v[44:47], v[36:39], v[144:159]
  s_waitcnt lgkmcnt(6)
  v_mfma_f32_32x32x16_bf16 v[96:111], v[56:59], v[48:51], v[96:111]
  ds_read_b128 v[80:83], v25 offset:0
  ds_read_b128 v[84:87], v25 offset:4096
  v_mfma_f32_32x32x16_bf16 v[112:127], v[56:59], v[52:55], v[112:127]
  ds_read_b64_tr_b16 v[88:89], v26 offset:12288
  ds_read_b64_tr_b16 v[90:91], v26 offset:13312
  v_mfma_f32_32x32x16_bf16 v[128:143], v[60:63], v[48:51], v[128:143]
  ds_read_b64_tr_b16 v[92:93], v27 offset:12288
  ds_read_b64_tr_b16 v[94:95], v27 offset:13312
  v_mfma_f32_32x32x16_bf16 v[144:159], v[60:63], v[52:55], v[144:159]
  s_cmp_lt_u32 s90, 6
  s_cbranch_scc1 L_q1_33
  s_waitcnt vmcnt(0)
L_q1_33:
  s_waitcnt vmcnt(8) lgkmcnt(0)
  v_mov_b32 v30, 1
  s_mov_b64 exec, 1
  ds_add_u32 v251, v30 offset:16
  s_mov_b64 exec, -1
  s_add_u32 s18, s18, 4
  s_add_u32 s19, s19, 32768
  s_cmp_eq_u32 s19, 98304
  s_cselect_b32 s19, 0, s19
  v_mfma_f32_32x32x16_bf16 v[96:111], v[72:75], v[64:67], v[96:111]
  v_add_u32 v22, s19, v16
  v_add_u32 v23, s19, v17
  v_mfma_f32_32x32x16_bf16 v[112:127], v[72:75], v[68:71], v[112:127]
  v_add_u32 v24, s19, v18
  v_add_u32 v25, s19, v19
  v_mfma_f32_32x32x16_bf16 v[128:143], v[76:79], v[64:67], v[128:143]
  v_add_u32 v26, s19, v20
  v_add_u32 v27, s19, v21
  v_mfma_f32_32x32x16_bf16 v[144:159], v[76:79], v[68:71], v[144:159]
  s_mov_b32 s97, 0
L_qp_38:
  ds_read_b32 v31, v251 offset:16
  s_waitcnt lgkmcnt(0)
  v_readfirstlane_b32 s96, v31
  s_add_u32 s97, s97, 1
  s_cmp_ge_u32 s96, s18
  s_cbranch_scc1 L_qpd_39
  s_cmp_gt_u32 s97, 240000
  s_cbranch_scc0 L_qp_38
L_qpd_39:
  v_mfma_f32_32x32x16_bf16 v[96:111], v[88:91], v[80:83], v[96:111]
  ds_read_b128 v[32:35], v22 offset:0
  ds_read_b128 v[36:39], v22 offset:4096
  ds_read_b64_tr_b16 v[40:41], v26 offset:0
  v_mfma_f32_32x32x16_bf16 v[112:127], v[88:91], v[84:87], v[112:127]
  ds_read_b64_tr_b16 v[42:43], v26 offset:1024
  ds_read_b64_tr_b16 v[44:45], v27 offset:0
  ds_read_b64_tr_b16 v[46:47], v27 offset:1024
  v_mfma_f32_32x32x16_bf16 v[128:143], v[92:95], v[80:83], v[128:143]
  ds_read_b128 v[48:51], v23 offset:0
  ds_read_b128 v[52:55], v23 offset:4096
  ds_read_b64_tr_b16 v[56:57], v26 offset:4096
  v_mfma_f32_32x32x16_bf16 v[144:159], v[92:95], v[84:87], v[144:159]
  ds_read_b64_tr_b16 v[58:59], v26 offset:5120
  ds_read_b64_tr_b16 v[60:61], v27 offset:4096
  ds_read_b64_tr_b16 v[62:63], v27 offset:5120
  s_cmp_lt_u32 s90, 5
  s_cbranch_scc0 L_q2_34
  s_mul_i32 s87, s39, 196608
  s_lshl_b32 s86, s39, 7
  s_add_u32 s17, s38, s16
  s_add_u32 m0, s17, 0
  s_nop 0
  buffer_load_dwordx4 v4, s[4:7], s86 offen lds
  s_add_u32 m0, s17, 16384
  s_nop 0
  buffer_load_dwordx4 v8, s[8:11], s87 offen lds
  s_add_u32 m0, s17, 1024
  s_nop 0
  buffer_load_dwordx4 v5, s[4:7], s86 offen lds
  s_add_u32 m0, s17, 17408
  s_nop 0
  buffer_load_dwordx4 v9, s[8:11], s87 offen lds
  s_add_u32 m0, s17, 2048
  s_nop 0
  buffer_load_dwordx4 v6, s[4:7], s86 offen lds
  s_add_u32 m0, s17, 18432
  s_nop 0
  buffer_load_dwordx4 v10, s[8:11], s87 offen lds
  s_add_u32 m0, s17, 3072
  s_nop 0
  buffer_load_dwordx4 v7, s[4:7], s86 offen lds
  s_add_u32 m0, s17, 19456
  s_nop 0
  buffer_load_dwordx4 v11, s[8:11], s87 offen lds
  s_add_u32 s39, s39, 1
  s_and_b32 s39, s39, 7
  s_add_u32 s16, s16, 32768
  s_cmp_eq_u32 s16, 98304
  s_cselect_b32 s16, 0, s16
L_q2_34:
  s_add_u32 s90, s90, 1
  s_cmp_lt_u32 s90, 8
  s_cbranch_scc1 L_qkv_32
  s_waitcnt lgkmcnt(0)
  v_mov_b32 v30, 1
  s_mov_b64 exec, 1
  ds_add_u32 v251, v30 offset:20
  s_mov_b64 exec, -1
  v_and_b32 v3, 31, v2
  v_lshrrev_b32 v12, 5, v2
  s_lshl_b32 s83, s36, 7
  s_lshl_b32 s84, s88, 6
  s_add_u32 s83, s83, s84
  v_add_u32 v3, s83, v3
  v_lshlrev_b32 v3, 5, v3
  v_lshl_add_u32 v3, v12, 4, v3
  s_and_b32 s83, s37, 3
  s_lshl_b32 s83, s83, 3
  s_lshl_b32 s84, s89, 2
  s_add_u32 s83, s83, s84
  s_lshl_b32 s83, s83, 16
  s_lshr_b32 s84, s37, 2
  s_lshl_b32 s84, s84, 21
  s_add_u32 s83, s83, s84
  v_add_u32 v3, s83, v3
  s_cmp_ge_u32 s37, 4
  s_cbranch_scc1 L_noqs
  v_mov_b32 v4, 0x3eb8aa3b
  v_mov_b32 v5, 0x3eb8aa3b
  v_pk_mul_f32 v[96:97], v[96:97], v[4:5]
  v_pk_mul_f32 v[98:99], v[98:99], v[4:5]
  v_pk_mul_f32 v[100:101], v[100:101], v[4:5]
  v_pk_mul_f32 v[102:103], v[102:103], v[4:5]
  v_pk_mul_f32 v[104:105], v[104:105], v[4:5]
  v_pk_mul_f32 v[106:107], v[106:107], v[4:5]
  v_pk_mul_f32 v[108:109], v[108:109], v[4:5]
  v_pk_mul_f32 v[110:111], v[110:111], v[4:5]
  v_pk_mul_f32 v[112:113], v[112:113], v[4:5]
  v_pk_mul_f32 v[114:115], v[114:115], v[4:5]
  v_pk_mul_f32 v[116:117], v[116:117], v[4:5]
  v_pk_mul_f32 v[118:119], v[118:119], v[4:5]
  v_pk_mul_f32 v[120:121], v[120:121], v[4:5]
  v_pk_mul_f32 v[122:123], v[122:123], v[4:5]
  v_pk_mul_f32 v[124:125], v[124:125], v[4:5]
  v_pk_mul_f32 v[126:127], v[126:127], v[4:5]
  v_pk_mul_f32 v[128:129], v[128:129], v[4:5]
  v_pk_mul_f32 v[130:131], v[130:131], v[4:5]
  v_pk_mul_f32 v[132:133], v[132:133], v[4:5]
  v_pk_mul_f32 v[134:135], v[134:135], v[4:5]
  v_pk_mul_f32 v[136:137], v[136:137], v[4:5]
  v_pk_mul_f32 v[138:139], v[138:139], v[4:5]
  v_pk_mul_f32 v[140:141], v[140:141], v[4:5]
  v_pk_mul_f32 v[142:143], v[142:143], v[4:5]
  v_pk_mul_f32 v[144:145], v[144:145], v[4:5]
  v_pk_mul_f32 v[146:147], v[146:147], v[4:5]
  v_pk_mul_f32 v[148:149], v[148:149], v[4:5]
  v_pk_mul_f32 v[150:151], v[150:151], v[4:5]
  v_pk_mul_f32 v[152:153], v[152:153], v[4:5]
  v_pk_mul_f32 v[154:155], v[154:155], v[4:5]
  v_pk_mul_f32 v[156:157], v[156:157], v[4:5]
  v_pk_mul_f32 v[158:159], v[158:159], v[4:5]
L_noqs:
  v_cvt_pk_bf16_f32 v160, v96, v97
  v_cvt_pk_bf16_f32 v161, v98, v99
  v_cvt_pk_bf16_f32 v162, v100, v101
  v_cvt_pk_bf16_f32 v163, v102, v103
  s_mov_b32 s85, 0
  buffer_store_dwordx4 v[160:163], v3, s[12:15], s85 offen offset:0 sc1
  v_cvt_pk_bf16_f32 v164, v104, v105
  v_cvt_pk_bf16_f32 v165, v106, v107
  v_cvt_pk_bf16_f32 v166, v108, v109
  v_cvt_pk_bf16_f32 v167, v110, v111
  s_mov_b32 s85, 65536
  buffer_store_dwordx4 v[164:167], v3, s[12:15], s85 offen offset:0 sc1
  v_cvt_pk_bf16_f32 v168, v112, v113
  v_cvt_pk_bf16_f32 v169, v114, v115
  v_cvt_pk_bf16_f32 v170, v116, v117
  v_cvt_pk_bf16_f32 v171, v118, v119
  s_mov_b32 s85, 0
  buffer_store_dwordx4 v[168:171], v3, s[12:15], s85 offen offset:1024 sc1
  v_cvt_pk_bf16_f32 v172, v120, v121
  v_cvt_pk_bf16_f32 v173, v122, v123
  v_cvt_pk_bf16_f32 v174, v124, v125
  v_cvt_pk_bf16_f32 v175, v126, v127
  s_mov_b32 s85, 65536
  buffer_store_dwordx4 v[172:175], v3, s[12:15], s85 offen offset:1024 sc1
  v_cvt_pk_bf16_f32 v176, v128, v129
  v_cvt_pk_bf16_f32 v177, v130, v131
  v_cvt_pk_bf16_f32 v178, v132, v133
  v_cvt_pk_bf16_f32 v179, v134, v135
  s_mov_b32 s85, 131072
  buffer_store_dwordx4 v[176:179], v3, s[12:15], s85 offen offset:0 sc1
  v_cvt_pk_bf16_f32 v180, v136, v137
  v_cvt_pk_bf16_f32 v181, v138, v139
  v_cvt_pk_bf16_f32 v182, v140, v141
  v_cvt_pk_bf16_f32 v183, v142, v143
  s_mov_b32 s85, 196608
  buffer_store_dwordx4 v[180:183], v3, s[12:15], s85 offen offset:0 sc1
  v_cvt_pk_bf16_f32 v184, v144, v145
  v_cvt_pk_bf16_f32 v185, v146, v147
  v_cvt_pk_bf16_f32 v186, v148, v149
  v_cvt_pk_bf16_f32 v187, v150, v151
  s_mov_b32 s85, 131072
  buffer_store_dwordx4 v[184:187], v3, s[12:15], s85 offen offset:1024 sc1
  v_cvt_pk_bf16_f32 v188, v152, v153
  v_cvt_pk_bf16_f32 v189, v154, v155
  v_cvt_pk_bf16_f32 v190, v156, v157
  v_cvt_pk_bf16_f32 v191, v158, v159
  s_mov_b32 s85, 196608
  buffer_store_dwordx4 v[188:191], v3, s[12:15], s85 offen offset:1024 sc1
  v_readfirstlane_b32 s68, v28
  v_readfirstlane_b32 s69, v29
  s_cmp_lg_u32 s68, 0
  s_cbranch_scc1 L_tokok_40
  s_mov_b32 s97, 0
L_tok_41:
  buffer_load_dwordx2 v[28:29], v252, s[64:67], 0 offen sc1
  s_waitcnt vmcnt(0)
  v_readfirstlane_b32 s68, v28
  v_readfirstlane_b32 s69, v29
  s_add_u32 s97, s97, 1
  s_cmp_lg_u32 s68, 0
  s_cbranch_scc1 L_tokd_42
  s_cmp_gt_u32 s97, 60000
  s_cbranch_scc1 L_tokd_42
  s_sleep 1
  s_branch L_tok_41
L_tokd_42:
L_tokok_40:
  s_lshl_b32 s83, s37, 1
  s_add_u32 s83, s83, s89
  s_lshl_b32 s83, s83, 5
  s_lshl_b32 s84, s36, 1
  s_add_u32 s84, s84, s88
  s_add_u32 s83, s83, s84
  s_lshl_b32 s83, s83, 6
  s_add_u32 s91, s83, 0xd04000
  v_mov_b32 v28, s68
  v_mov_b32 v29, s69
  s_waitcnt vmcnt(0)
  s_mov_b64 exec, 1
  buffer_store_dwordx2 v[28:29], v252, s[12:15], s91 offen sc1
  s_mov_b64 exec, -1
  v_mov_b32 v30, 1
  s_mov_b64 exec, 1
  ds_add_u32 v251, v30 offset:40
  s_mov_b64 exec, -1
  s_branch L_a_p1done
L_vpath:
  s_waitcnt vmcnt(17)
  v_mov_b32 v30, 1
  s_mov_b64 exec, 1
  ds_add_u32 v251, v30 offset:16
  s_mov_b64 exec, -1
  s_mov_b32 s18, 4
  s_mov_b32 s97, 0
L_qp_47:
  ds_read_b32 v31, v251 offset:16
  s_waitcnt lgkmcnt(0)
  v_readfirstlane_b32 s96, v31
  s_add_u32 s97, s97, 1
  s_cmp_ge_u32 s96, s18
  s_cbranch_scc1 L_qpd_48
  s_cmp_gt_u32 s97, 240000
  s_cbranch_scc0 L_qp_47
L_qpd_48:
  ds_read_b128 v[32:35], v22 offset:0
  ds_read_b128 v[36:39], v22 offset:4096
  ds_read_b64_tr_b16 v[40:41], v26 offset:0
  ds_read_b64_tr_b16 v[42:43], v26 offset:1024
  ds_read_b64_tr_b16 v[44:45], v27 offset:0
  ds_read_b64_tr_b16 v[46:47], v27 offset:1024
  ds_read_b128 v[48:51], v23 offset:0
  ds_read_b128 v[52:55], v23 offset:4096
  ds_read_b64_tr_b16 v[56:57], v26 offset:4096
  ds_read_b64_tr_b16 v[58:59], v26 offset:5120
  ds_read_b64_tr_b16 v[60:61], v27 offset:4096
  ds_read_b64_tr_b16 v[62:63], v27 offset:5120
  s_mov_b32 s90, 0
  s_mov_b32 s19, 0
L_qkv_43:
  s_waitcnt lgkmcnt(6)
  v_mfma_f32_32x32x16_bf16 v[96:111], v[32:35], v[40:43], v[96:111]
  ds_read_b128 v[64:67], v24 offset:0
  ds_read_b128 v[68:71], v24 offset:4096
  v_mfma_f32_32x32x16_bf16 v[112:127], v[36:39], v[40:43], v[112:127]
  ds_read_b64_tr_b16 v[72:73], v26 offset:8192
  ds_read_b64_tr_b16 v[74:75], v26 offset:9216
  v_mfma_f32_32x32x16_bf16 v[128:143], v[32:35], v[44:47], v[128:143]
  ds_read_b64_tr_b16 v[76:77], v27 offset:8192
  ds_read_b64_tr_b16 v[78:79], v27 offset:9216
  v_mfma_f32_32x32x16_bf16 v[144:159], v[36:39], v[44:47], v[144:159]
  s_waitcnt lgkmcnt(6)
  v_mfma_f32_32x32x16_bf16 v[96:111], v[48:51], v[56:59], v[96:111]
  ds_read_b128 v[80:83], v25 offset:0
  ds_read_b128 v[84:87], v25 offset:4096
  v_mfma_f32_32x32x16_bf16 v[112:127], v[52:55], v[56:59], v[112:127]
  ds_read_b64_tr_b16 v[88:89], v26 offset:12288
  ds_read_b64_tr_b16 v[90:91], v26 offset:13312
  v_mfma_f32_32x32x16_bf16 v[128:143], v[48:51], v[60:63], v[128:143]
  ds_read_b64_tr_b16 v[92:93], v27 offset:12288
  ds_read_b64_tr_b16 v[94:95], v27 offset:13312
  v_mfma_f32_32x32x16_bf16 v[144:159], v[52:55], v[60:63], v[144:159]
  s_cmp_lt_u32 s90, 6
  s_cbranch_scc1 L_q1_44
  s_waitcnt vmcnt(0)
L_q1_44:
  s_waitcnt vmcnt(8) lgkmcnt(0)
  v_mov_b32 v30, 1
  s_mov_b64 exec, 1
  ds_add_u32 v251, v30 offset:16
  s_mov_b64 exec, -1
  s_add_u32 s18, s18, 4
  s_add_u32 s19, s19, 32768
  s_cmp_eq_u32 s19, 98304
  s_cselect_b32 s19, 0, s19
  v_mfma_f32_32x32x16_bf16 v[96:111], v[64:67], v[72:75], v[96:111]
  v_add_u32 v22, s19, v16
  v_add_u32 v23, s19, v17
  v_mfma_f32_32x32x16_bf16 v[112:127], v[68:71], v[72:75], v[112:127]
  v_add_u32 v24, s19, v18
  v_add_u32 v25, s19, v19
  v_mfma_f32_32x32x16_bf16 v[128:143], v[64:67], v[76:79], v[128:143]
  v_add_u32 v26, s19, v20
  v_add_u32 v27, s19, v21
  v_mfma_f32_32x32x16_bf16 v[144:159], v[68:71], v[76:79], v[144:159]
  s_mov_b32 s97, 0
L_qp_49:
  ds_read_b32 v31, v251 offset:16
  s_waitcnt lgkmcnt(0)
  v_readfirstlane_b32 s96, v31
  s_add_u32 s97, s97, 1
  s_cmp_ge_u32 s96, s18
  s_cbranch_scc1 L_qpd_50
  s_cmp_gt_u32 s97, 240000
  s_cbranch_scc0 L_qp_49
L_qpd_50:
  v_mfma_f32_32x32x16_bf16 v[96:111], v[80:83], v[88:91], v[96:111]
  ds_read_b128 v[32:35], v22 offset:0
  ds_read_b128 v[36:39], v22 offset:4096
  ds_read_b64_tr_b16 v[40:41], v26 offset:0
  v_mfma_f32_32x32x16_bf16 v[112:127], v[84:87], v[88:91], v[112:127]
  ds_read_b64_tr_b16 v[42:43], v26 offset:1024
  ds_read_b64_tr_b16 v[44:45], v27 offset:0
  ds_read_b64_tr_b16 v[46:47], v27 offset:1024
  v_mfma_f32_32x32x16_bf16 v[128:143], v[80:83], v[92:95], v[128:143]
  ds_read_b128 v[48:51], v23 offset:0
  ds_read_b128 v[52:55], v23 offset:4096
  ds_read_b64_tr_b16 v[56:57], v26 offset:4096
  v_mfma_f32_32x32x16_bf16 v[144:159], v[84:87], v[92:95], v[144:159]
  ds_read_b64_tr_b16 v[58:59], v26 offset:5120
  ds_read_b64_tr_b16 v[60:61], v27 offset:4096
  ds_read_b64_tr_b16 v[62:63], v27 offset:5120
  s_cmp_lt_u32 s90, 5
  s_cbranch_scc0 L_q2_45
  s_mul_i32 s87, s39, 196608
  s_lshl_b32 s86, s39, 7
  s_add_u32 s17, s38, s16
  s_add_u32 m0, s17, 0
  s_nop 0
  buffer_load_dwordx4 v4, s[4:7], s86 offen lds
  s_add_u32 m0, s17, 16384
  s_nop 0
  buffer_load_dwordx4 v8, s[8:11], s87 offen lds
  s_add_u32 m0, s17, 1024
  s_nop 0
  buffer_load_dwordx4 v5, s[4:7], s86 offen lds
  s_add_u32 m0, s17, 17408
  s_nop 0
  buffer_load_dwordx4 v9, s[8:11], s87 offen lds
  s_add_u32 m0, s17, 2048
  s_nop 0
  buffer_load_dwordx4 v6, s[4:7], s86 offen lds
  s_add_u32 m0, s17, 18432
  s_nop 0
  buffer_load_dwordx4 v10, s[8:11], s87 offen lds
  s_add_u32 m0, s17, 3072
  s_nop 0
  buffer_load_dwordx4 v7, s[4:7], s86 offen lds
  s_add_u32 m0, s17, 19456
  s_nop 0
  buffer_load_dwordx4 v11, s[8:11], s87 offen lds
  s_add_u32 s39, s39, 1
  s_and_b32 s39, s39, 7
  s_add_u32 s16, s16, 32768
  s_cmp_eq_u32 s16, 98304
  s_cselect_b32 s16, 0, s16
L_q2_45:
  s_add_u32 s90, s90, 1
  s_cmp_lt_u32 s90, 8
  s_cbranch_scc1 L_qkv_43
  s_waitcnt lgkmcnt(0)
  v_mov_b32 v30, 1
  s_mov_b64 exec, 1
  ds_add_u32 v251, v30 offset:20
  s_mov_b64 exec, -1
  v_and_b32 v3, 15, v2
  v_lshrrev_b32 v12, 5, v2
  v_lshlrev_b32 v3, 4, v3
  v_lshl_add_u32 v3, v12, 8, v3
  v_bfe_u32 v12, v2, 4, 1
  v_lshl_add_u32 v3, v12, 16, v3
  s_and_b32 s83, s37, 3
  s_lshl_b32 s83, s83, 3
  s_lshl_b32 s84, s89, 2
  s_add_u32 s83, s83, s84
  s_lshl_b32 s83, s83, 16
  s_lshl_b32 s84, s36, 2
  s_lshl_b32 s85, s88, 1
  s_add_u32 s84, s84, s85
  s_lshl_b32 s84, s84, 10
  s_add_u32 s83, s83, s84
  s_add_u32 s83, s83, 0x400000
  v_add_u32 v3, s83, v3
  v_cvt_pk_bf16_f32 v160, v96, v97
  v_cvt_pk_bf16_f32 v161, v98, v99
  v_cvt_pk_bf16_f32 v162, v100, v101
  v_cvt_pk_bf16_f32 v163, v102, v103
  s_mov_b32 s85, 0
  buffer_store_dwordx4 v[160:163], v3, s[12:15], s85 offen offset:0 sc1
  v_cvt_pk_bf16_f32 v164, v104, v105
  v_cvt_pk_bf16_f32 v165, v106, v107
  v_cvt_pk_bf16_f32 v166, v108, v109
  v_cvt_pk_bf16_f32 v167, v110, v111
  s_mov_b32 s85, 0
  buffer_store_dwordx4 v[164:167], v3, s[12:15], s85 offen offset:512 sc1
  v_cvt_pk_bf16_f32 v168, v112, v113
  v_cvt_pk_bf16_f32 v169, v114, v115
  v_cvt_pk_bf16_f32 v170, v116, v117
  v_cvt_pk_bf16_f32 v171, v118, v119
  s_mov_b32 s85, 0
  buffer_store_dwordx4 v[168:171], v3, s[12:15], s85 offen offset:1024 sc1
  v_cvt_pk_bf16_f32 v172, v120, v121
  v_cvt_pk_bf16_f32 v173, v122, v123
  v_cvt_pk_bf16_f32 v174, v124, v125
  v_cvt_pk_bf16_f32 v175, v126, v127
  s_mov_b32 s85, 0
  buffer_store_dwordx4 v[172:175], v3, s[12:15], s85 offen offset:1536 sc1
  v_cvt_pk_bf16_f32 v176, v128, v129
  v_cvt_pk_bf16_f32 v177, v130, v131
  v_cvt_pk_bf16_f32 v178, v132, v133
  v_cvt_pk_bf16_f32 v179, v134, v135
  s_mov_b32 s85, 131072
  buffer_store_dwordx4 v[176:179], v3, s[12:15], s85 offen offset:0 sc1
  v_cvt_pk_bf16_f32 v180, v136, v137
  v_cvt_pk_bf16_f32 v181, v138, v139
  v_cvt_pk_bf16_f32 v182, v140, v141
  v_cvt_pk_bf16_f32 v183, v142, v143
  s_mov_b32 s85, 131072
  buffer_store_dwordx4 v[180:183], v3, s[12:15], s85 offen offset:512 sc1
  v_cvt_pk_bf16_f32 v184, v144, v145
  v_cvt_pk_bf16_f32 v185, v146, v147
  v_cvt_pk_bf16_f32 v186, v148, v149
  v_cvt_pk_bf16_f32 v187, v150, v151
  s_mov_b32 s85, 131072
  buffer_store_dwordx4 v[184:187], v3, s[12:15], s85 offen offset:1024 sc1
  v_cvt_pk_bf16_f32 v188, v152, v153
  v_cvt_pk_bf16_f32 v189, v154, v155
  v_cvt_pk_bf16_f32 v190, v156, v157
  v_cvt_pk_bf16_f32 v191, v158, v159
  s_mov_b32 s85, 131072
  buffer_store_dwordx4 v[188:191], v3, s[12:15], s85 offen offset:1536 sc1
  v_readfirstlane_b32 s68, v28
  v_readfirstlane_b32 s69, v29
  s_cmp_lg_u32 s68, 0
  s_cbranch_scc1 L_tokok_51
  s_mov_b32 s97, 0
L_tok_52:
  buffer_load_dwordx2 v[28:29], v252, s[64:67], 0 offen sc1
  s_waitcnt vmcnt(0)
  v_readfirstlane_b32 s68, v28
  v_readfirstlane_b32 s69, v29
  s_add_u32 s97, s97, 1
  s_cmp_lg_u32 s68, 0
  s_cbranch_scc1 L_tokd_53
  s_cmp_gt_u32 s97, 60000
  s_cbranch_scc1 L_tokd_53
  s_sleep 1
  s_branch L_tok_52
L_tokd_53:
L_tokok_51:
  s_lshl_b32 s83, s37, 1
  s_add_u32 s83, s83, s89
  s_lshl_b32 s83, s83, 5
  s_lshl_b32 s84, s36, 1
  s_add_u32 s84, s84, s88
  s_add_u32 s83, s83, s84
  s_lshl_b32 s83, s83, 6
  s_add_u32 s91, s83, 0xd04000
  v_mov_b32 v28, s68
  v_mov_b32 v29, s69
  s_waitcnt vmcnt(0)
  s_mov_b64 exec, 1
  buffer_store_dwordx2 v[28:29], v252, s[12:15], s91 offen sc1
  s_mov_b64 exec, -1
  v_mov_b32 v30, 1
  s_mov_b64 exec, 1
  ds_add_u32 v251, v30 offset:40
  s_mov_b64 exec, -1
  s_branch L_a_p1done
L_a_noqkv:
  v_mov_b32 v30, 1
  s_mov_b64 exec, 1
  ds_add_u32 v251, v30 offset:20
  s_mov_b64 exec, -1
  s_mov_b32 s76, s48
  s_and_b32 s77, s49, 0xffff
  s_mov_b32 s78, 0x560000
  s_mov_b32 s79, 0x00020000
  s_mov_b32 s84, s52
  s_and_b32 s85, s53, 0xffff
  s_mov_b32 s86, 0x560000
  s_mov_b32 s87, 0x00020000
  s_mov_b32 s88, s44
  s_and_b32 s89, s45, 0xffff
  s_mov_b32 s90, 0x80000
  s_mov_b32 s91, 0x00020000
  s_setprio 0
  s_sub_u32 s92, s2, 192
  s_lshl_b32 s92, s92, 2
  s_add_u32 s92, s92, s3
  s_mul_i32 s93, s92, 22016
  v_lshlrev_b32 v13, 7, v2
  s_lshl_b32 s94, s92, 11
  s_mov_b32 s97, 0
L_lw_54:
  ds_read_b32 v31, v251 offset:32
  s_waitcnt lgkmcnt(0)
  v_readfirstlane_b32 s96, v31
  s_add_u32 s97, s97, 1
  s_cmp_ge_u32 s96, 4
  s_cbranch_scc1 L_lwd_55
  s_cmp_gt_u32 s97, 240000
  s_cbranch_scc1 L_lwd_55
  s_branch L_lw_54
L_lwd_55:
  s_add_u32 s95, s93, 0
  buffer_load_dword v32, v13, s[76:79], s95 offen
  s_add_u32 s95, s93, 8192
  buffer_load_dword v33, v13, s[76:79], s95 offen
  s_add_u32 s95, s93, 16384
  buffer_load_dword v34, v13, s[76:79], s95 offen
  s_add_u32 s95, s93, 0
  buffer_load_dword v36, v13, s[84:87], s95 offen
  s_add_u32 s95, s93, 8192
  buffer_load_dword v37, v13, s[84:87], s95 offen
  s_add_u32 s95, s93, 16384
  buffer_load_dword v38, v13, s[84:87], s95 offen
  v_cmp_gt_u32 vcc, 16, v2
  s_and_saveexec_b64 s[92:93], vcc
  buffer_load_dword v40, v13, s[88:91], s94 offen
  s_mov_b64 exec, -1
L_a_p1done:
  s_setprio 2
  s_lshl_b32 s70, s81, 2
  s_lshr_b32 s83, s82, 3
  s_add_u32 s70, s70, s83
  s_and_b32 s83, s82, 7
  s_lshl_b32 s71, s83, 3
  s_lshl_b32 s83, s3, 1
  s_add_u32 s72, s71, s83
  v_and_b32 v3, 31, v2
  v_lshrrev_b32 v4, 5, v2
  v_lshlrev_b32 v5, 5, v3
  v_lshl_add_u32 v5, v4, 4, v5
  s_lshl_b32 s83, s70, 16
  v_add_u32 v5, s83, v5
  v_and_b32 v6, 15, v2
  v_lshlrev_b32 v6, 4, v6
  v_lshl_add_u32 v6, v4, 8, v6
  v_add_u32 v9, 139264, v6
  v_add_u32 v6, s83, v6
  v_add_u32 v6, 0x400000, v6
  v_lshlrev_b32 v7, 4, v2
  s_lshl_b32 s83, s70, 10
  s_add_u32 s83, s83, 0x900000
  v_add_u32 v7, s83, v7
  v_lshlrev_b32 v8, 2, v3
  v_add_u32 v8, 0x800000, v8
  v_mov_b32 v240, 0xf149f2ca
  v_mov_b32 v248, 0x3eb8aa3b
  v_mov_b32 v249, 0x3eb8aa3b
  v_lshlrev_b32 v10, 2, v4
  v_add_u32 v11, 0, v10
  v_cmp_le_u32 vcc, v11, v3
  s_nop 1
  v_cndmask_b32 v80, 0, v240, vcc
  v_cndmask_b32 v96, v240, v252, vcc
  v_add_u32 v11, 1, v10
  v_cmp_le_u32 vcc, v11, v3
  s_nop 1
  v_cndmask_b32 v81, 0, v240, vcc
  v_cndmask_b32 v97, v240, v252, vcc
  v_add_u32 v11, 2, v10
  v_cmp_le_u32 vcc, v11, v3
  s_nop 1
  v_cndmask_b32 v82, 0, v240, vcc
  v_cndmask_b32 v98, v240, v252, vcc
  v_add_u32 v11, 3, v10
  v_cmp_le_u32 vcc, v11, v3
  s_nop 1
  v_cndmask_b32 v83, 0, v240, vcc
  v_cndmask_b32 v99, v240, v252, vcc
  v_add_u32 v11, 8, v10
  v_cmp_le_u32 vcc, v11, v3
  s_nop 1
  v_cndmask_b32 v84, 0, v240, vcc
  v_cndmask_b32 v100, v240, v252, vcc
  v_add_u32 v11, 9, v10
  v_cmp_le_u32 vcc, v11, v3
  s_nop 1
  v_cndmask_b32 v85, 0, v240, vcc
  v_cndmask_b32 v101, v240, v252, vcc
  v_add_u32 v11, 10, v10
  v_cmp_le_u32 vcc, v11, v3
  s_nop 1
  v_cndmask_b32 v86, 0, v240, vcc
  v_cndmask_b32 v102, v240, v252, vcc
  v_add_u32 v11, 11, v10
  v_cmp_le_u32 vcc, v11, v3
  s_nop 1
  v_cndmask_b32 v87, 0, v240, vcc
  v_cndmask_b32 v103, v240, v252, vcc
  v_add_u32 v11, 16, v10
  v_cmp_le_u32 vcc, v11, v3
  s_nop 1
  v_cndmask_b32 v88, 0, v240, vcc
  v_cndmask_b32 v104, v240, v252, vcc
  v_add_u32 v11, 17, v10
  v_cmp_le_u32 vcc, v11, v3
  s_nop 1
  v_cndmask_b32 v89, 0, v240, vcc
  v_cndmask_b32 v105, v240, v252, vcc
  v_add_u32 v11, 18, v10
  v_cmp_le_u32 vcc, v11, v3
  s_nop 1
  v_cndmask_b32 v90, 0, v240, vcc
  v_cndmask_b32 v106, v240, v252, vcc
  v_add_u32 v11, 19, v10
  v_cmp_le_u32 vcc, v11, v3
  s_nop 1
  v_cndmask_b32 v91, 0, v240, vcc
  v_cndmask_b32 v107, v240, v252, vcc
  v_add_u32 v11, 24, v10
  v_cmp_le_u32 vcc, v11, v3
  s_nop 1
  v_cndmask_b32 v92, 0, v240, vcc
  v_cndmask_b32 v108, v240, v252, vcc
  v_add_u32 v11, 25, v10
  v_cmp_le_u32 vcc, v11, v3
  s_nop 1
  v_cndmask_b32 v93, 0, v240, vcc
  v_cndmask_b32 v109, v240, v252, vcc
  v_add_u32 v11, 26, v10
  v_cmp_le_u32 vcc, v11, v3
  s_nop 1
  v_cndmask_b32 v94, 0, v240, vcc
  v_cndmask_b32 v110, v240, v252, vcc
  v_add_u32 v11, 27, v10
  v_cmp_le_u32 vcc, v11, v3
  s_nop 1
  v_cndmask_b32 v95, 0, v240, vcc
  v_cndmask_b32 v111, v240, v252, vcc
  v_mov_b32 v208, 0x3f803f80
  v_mov_b32 v209, 0x3f803f80
  v_mov_b32 v210, 0x3f803f80
  v_mov_b32 v211, 0x3f803f80
  v_mov_b32 v212, 0x3f803f80
  v_mov_b32 v213, 0x3f803f80
  v_mov_b32 v214, 0x3f803f80
  v_mov_b32 v215, 0x3f803f80
  v_mov_b32 v216, 0x3f803f80
  v_mov_b32 v217, 0x3f803f80
  v_mov_b32 v218, 0x3f803f80
  v_mov_b32 v219, 0x3f803f80
  v_mov_b32 v220, 0x3f803f80
  v_mov_b32 v221, 0x3f803f80
  v_mov_b32 v222, 0x3f803f80
  v_mov_b32 v223, 0x3f803f80
  v_cmp_gt_u32 s[74:75], 16, v3
  s_lshr_b32 s84, s70, 2
  s_lshr_b32 s85, s72, 1
  s_lshl_b32 s86, s84, 5
  s_add_u32 s86, s86, s85
  s_lshl_b32 s86, s86, 6
  s_add_u32 s86, s86, 0xd04000
  v_mov_b32 v12, s86
  s_add_u32 s86, s85, 0
  s_max_u32 s86, s86, 4
  s_sub_u32 s86, s86, 4
  s_add_u32 s87, s84, 8
  s_lshl_b32 s87, s87, 5
  s_add_u32 s86, s86, s87
  s_lshl_b32 s86, s86, 6
  s_add_u32 s86, s86, 0xd04000
  v_writelane_b32 v12, s86, 1
  s_add_u32 s86, s85, 1
  s_max_u32 s86, s86, 4
  s_sub_u32 s86, s86, 4
  s_add_u32 s87, s84, 8
  s_lshl_b32 s87, s87, 5
  s_add_u32 s86, s86, s87
  s_lshl_b32 s86, s86, 6
  s_add_u32 s86, s86, 0xd04000
  v_writelane_b32 v12, s86, 2
  s_add_u32 s86, s85, 2
  s_max_u32 s86, s86, 4
  s_sub_u32 s86, s86, 4
  s_add_u32 s87, s84, 8
  s_lshl_b32 s87, s87, 5
  s_add_u32 s86, s86, s87
  s_lshl_b32 s86, s86, 6
  s_add_u32 s86, s86, 0xd04000
  v_writelane_b32 v12, s86, 3
  s_add_u32 s86, s85, 3
  s_max_u32 s86, s86, 4
  s_sub_u32 s86, s86, 4
  s_add_u32 s87, s84, 8
  s_lshl_b32 s87, s87, 5
  s_add_u32 s86, s86, s87
  s_lshl_b32 s86, s86, 6
  s_add_u32 s86, s86, 0xd04000
  v_writelane_b32 v12, s86, 4
  s_add_u32 s86, s85, 4
  s_max_u32 s86, s86, 4
  s_sub_u32 s86, s86, 4
  s_add_u32 s87, s84, 8
  s_lshl_b32 s87, s87, 5
  s_add_u32 s86, s86, s87
  s_lshl_b32 s86, s86, 6
  s_add_u32 s86, s86, 0xd04000
  v_writelane_b32 v12, s86, 5
  s_lshr_b32 s86, s71, 1
  s_lshl_b32 s87, s3, 1
  s_add_u32 s86, s86, s87
  s_add_u32 s86, s86, 0
  s_max_u32 s86, s86, 4
  s_sub_u32 s86, s86, 4
  s_add_u32 s87, s84, 16
  s_lshl_b32 s87, s87, 5
  s_add_u32 s86, s86, s87
  s_lshl_b32 s86, s86, 6
  s_add_u32 s86, s86, 0xd04000
  v_writelane_b32 v12, s86, 6
  s_lshr_b32 s86, s71, 1
  s_lshl_b32 s87, s3, 1
  s_add_u32 s86, s86, s87
  s_add_u32 s86, s86, 1
  s_max_u32 s86, s86, 4
  s_sub_u32 s86, s86, 4
  s_add_u32 s87, s84, 16
  s_lshl_b32 s87, s87, 5
  s_add_u32 s86, s86, s87
  s_lshl_b32 s86, s86, 6
  s_add_u32 s86, s86, 0xd04000
  v_writelane_b32 v12, s86, 7
  s_lshl_b32 s86, s72, 2
  s_add_u32 s86, s86, 0
  s_lshl_b32 s86, s86, 6
  s_add_u32 s86, s86, 0xd00000
  v_writelane_b32 v12, s86, 8
  s_lshl_b32 s86, s72, 2
  s_add_u32 s86, s86, 1
  s_lshl_b32 s86, s86, 6
  s_add_u32 s86, s86, 0xd00000
  v_writelane_b32 v12, s86, 9
  s_lshl_b32 s86, s72, 2
  s_add_u32 s86, s86, 2
  s_lshl_b32 s86, s86, 6
  s_add_u32 s86, s86, 0xd00000
  v_writelane_b32 v12, s86, 10
  s_lshl_b32 s86, s72, 2
  s_add_u32 s86, s86, 3
  s_lshl_b32 s86, s86, 6
  s_add_u32 s86, s86, 0xd00000
  v_writelane_b32 v12, s86, 11
  s_lshl_b32 s86, s72, 2
  s_add_u32 s86, s86, 4
  s_lshl_b32 s86, s86, 6
  s_add_u32 s86, s86, 0xd00000
  v_writelane_b32 v12, s86, 12
  s_lshl_b32 s86, s72, 2
  s_add_u32 s86, s86, 5
  s_lshl_b32 s86, s86, 6
  s_add_u32 s86, s86, 0xd00000
  v_writelane_b32 v12, s86, 13
  s_lshl_b32 s86, s72, 2
  s_add_u32 s86, s86, 6
  s_lshl_b32 s86, s86, 6
  s_add_u32 s86, s86, 0xd00000
  v_writelane_b32 v12, s86, 14
  s_lshl_b32 s86, s72, 2
  s_add_u32 s86, s86, 7
  s_lshl_b32 s86, s86, 6
  s_add_u32 s86, s86, 0xd00000
  v_writelane_b32 v12, s86, 15
  s_mov_b32 s97, 0
L_tok_56:
  buffer_load_dwordx2 v[14:15], v252, s[64:67], 0 offen sc1
  s_waitcnt vmcnt(0)
  v_readfirstlane_b32 s68, v14
  v_readfirstlane_b32 s69, v15
  s_add_u32 s97, s97, 1
  s_cmp_lg_u32 s68, 0
  s_cbranch_scc1 L_tokd_57
  s_cmp_gt_u32 s97, 60000
  s_cbranch_scc1 L_tokd_57
  s_sleep 1
  s_branch L_tok_56
L_tokd_57:
  buffer_load_dwordx2 v[14:15], v12, s[12:15], 0 offen sc1
  s_waitcnt vmcnt(0)
  s_mov_b32 s97, 0
  v_cmp_eq_u64 vcc, s[68:69], v[14:15]
  s_cmp_eq_u64 vcc, exec
  s_cbranch_scc1 L_fld_61
  s_andn2_b64 s[94:95], exec, vcc
  s_ff1_i32_b64 s96, s[94:95]
  s_lshl_b64 s[94:95], 1, s96
  s_mov_b64 exec, s[94:95]
L_fl1_59:
  s_sleep 1
  buffer_load_dwordx2 v[14:15], v12, s[12:15], 0 offen sc1
  s_add_u32 s97, s97, 1
  s_waitcnt vmcnt(0)
  v_cmp_eq_u64 vcc, s[68:69], v[14:15]
  s_cmp_eq_u64 vcc, exec
  s_cbranch_scc1 L_fl2_60
  s_cmp_gt_u32 s97, 60000
  s_cbranch_scc0 L_fl1_59
L_fl2_60:
  s_mov_b64 exec, -1
L_fl_58:
  v_cmp_eq_u64 vcc, s[68:69], v[14:15]
  s_cmp_eq_u64 vcc, exec
  s_cbranch_scc1 L_fld_61
  s_add_u32 s97, s97, 1
  s_cmp_gt_u32 s97, 60000
  s_cbranch_scc1 L_fld_61
  s_andn2_b64 exec, exec, vcc
  buffer_load_dwordx2 v[14:15], v12, s[12:15], 0 offen sc1
  s_mov_b64 exec, -1
  s_waitcnt vmcnt(0)
  s_branch L_fl_58
L_fld_61:
  s_mov_b64 exec, s[74:75]
  s_lshl_b32 s83, s3, 2
  s_add_u32 s83, s83, s71
  s_add_u32 s83, s83, 0
  s_max_u32 s83, s83, 8
  s_sub_u32 s83, s83, 8
  s_lshl_b32 s83, s83, 10
  buffer_load_dwordx4 v[32:35], v6, s[12:15], s83 offen sc1
  buffer_load_dwordx4 v[36:39], v6, s[12:15], s83 offen offset:512 sc1
  s_lshl_b32 s83, s3, 2
  s_add_u32 s83, s83, s71
  s_add_u32 s83, s83, 1
  s_max_u32 s83, s83, 8
  s_sub_u32 s83, s83, 8
  s_lshl_b32 s83, s83, 10
  buffer_load_dwordx4 v[40:43], v6, s[12:15], s83 offen sc1
  buffer_load_dwordx4 v[44:47], v6, s[12:15], s83 offen offset:512 sc1
  s_lshl_b32 s83, s3, 2
  s_add_u32 s83, s83, s71
  s_add_u32 s83, s83, 2
  s_max_u32 s83, s83, 8
  s_sub_u32 s83, s83, 8
  s_lshl_b32 s83, s83, 10
  buffer_load_dwordx4 v[48:51], v6, s[12:15], s83 offen sc1
  buffer_load_dwordx4 v[52:55], v6, s[12:15], s83 offen offset:512 sc1
  s_lshl_b32 s83, s3, 2
  s_add_u32 s83, s83, s71
  s_add_u32 s83, s83, 3
  s_max_u32 s83, s83, 8
  s_sub_u32 s83, s83, 8
  s_lshl_b32 s83, s83, 10
  buffer_load_dwordx4 v[56:59], v6, s[12:15], s83 offen sc1
  buffer_load_dwordx4 v[60:63], v6, s[12:15], s83 offen offset:512 sc1
  s_mov_b64 exec, -1
  s_lshl_b32 s83, s72, 10
  buffer_load_dwordx4 v[200:203], v5, s[12:15], s83 offen sc1
  buffer_load_dwordx4 v[204:207], v5, s[12:15], s83 offen offset:1024 sc1
  s_add_u32 s83, s72, 0
  s_max_u32 s83, s83, 8
  s_sub_u32 s83, s83, 8
  s_lshl_b32 s83, s83, 10
  s_add_u32 s83, s83, 0x200000
  buffer_load_dwordx4 v[160:163], v5, s[12:15], s83 offen sc1
  s_add_u32 s83, s72, 1
  s_max_u32 s83, s83, 8
  s_sub_u32 s83, s83, 8
  s_lshl_b32 s83, s83, 10
  s_add_u32 s83, s83, 0x200000
  buffer_load_dwordx4 v[164:167], v5, s[12:15], s83 offen sc1
  s_add_u32 s83, s72, 2
  s_max_u32 s83, s83, 8
  s_sub_u32 s83, s83, 8
  s_lshl_b32 s83, s83, 10
  s_add_u32 s83, s83, 0x200000
  buffer_load_dwordx4 v[168:171], v5, s[12:15], s83 offen sc1
  s_add_u32 s83, s72, 3
  s_max_u32 s83, s83, 8
  s_sub_u32 s83, s83, 8
  s_lshl_b32 s83, s83, 10
  s_add_u32 s83, s83, 0x200000
  buffer_load_dwordx4 v[172:175], v5, s[12:15], s83 offen sc1
  s_add_u32 s83, s72, 4
  s_max_u32 s83, s83, 8
  s_sub_u32 s83, s83, 8
  s_lshl_b32 s83, s83, 10
  s_add_u32 s83, s83, 0x200000
  buffer_load_dwordx4 v[176:179], v5, s[12:15], s83 offen sc1
  s_add_u32 s83, s72, 5
  s_max_u32 s83, s83, 8
  s_sub_u32 s83, s83, 8
  s_lshl_b32 s83, s83, 10
  s_add_u32 s83, s83, 0x200000
  buffer_load_dwordx4 v[180:183], v5, s[12:15], s83 offen sc1
  s_add_u32 s83, s72, 6
  s_max_u32 s83, s83, 8
  s_sub_u32 s83, s83, 8
  s_lshl_b32 s83, s83, 10
  s_add_u32 s83, s83, 0x200000
  buffer_load_dwordx4 v[184:187], v5, s[12:15], s83 offen sc1
  s_add_u32 s83, s72, 7
  s_max_u32 s83, s83, 8
  s_sub_u32 s83, s83, 8
  s_lshl_b32 s83, s83, 10
  s_add_u32 s83, s83, 0x200000
  buffer_load_dwordx4 v[188:191], v5, s[12:15], s83 offen sc1
  s_add_u32 s83, s72, 8
  s_max_u32 s83, s83, 8
  s_sub_u32 s83, s83, 8
  s_lshl_b32 s83, s83, 10
  s_add_u32 s83, s83, 0x200000
  buffer_load_dwordx4 v[192:195], v5, s[12:15], s83 offen sc1
  s_add_u32 s83, s72, 9
  s_max_u32 s83, s83, 8
  s_sub_u32 s83, s83, 8
  s_lshl_b32 s83, s83, 10
  s_add_u32 s83, s83, 0x200000
  buffer_load_dwordx4 v[196:199], v5, s[12:15], s83 offen sc1
  s_lshl_b32 s83, s72, 7
  buffer_load_dword v242, v8, s[12:15], s83 offen sc1
  buffer_load_dword v243, v8, s[12:15], s83 offen offset:128 sc1
  s_waitcnt vmcnt(14)
  s_lshl_b32 s83, s3, 12
  v_add_u32 v11, s83, v9
  s_mov_b64 exec, s[74:75]
  ds_write_b128 v11, v[32:35] offset:0
  ds_write_b128 v11, v[36:39] offset:512
  ds_write_b128 v11, v[40:43] offset:1024
  ds_write_b128 v11, v[44:47] offset:1536
  ds_write_b128 v11, v[48:51] offset:2048
  ds_write_b128 v11, v[52:55] offset:2560
  ds_write_b128 v11, v[56:59] offset:3072
  ds_write_b128 v11, v[60:63] offset:3584
  s_mov_b64 exec, -1
  s_waitcnt lgkmcnt(0)
  v_mov_b32 v14, 1
  s_mov_b64 exec, 1
  ds_add_u32 v251, v14 offset:8
  s_mov_b64 exec, -1
  s_mov_b32 s97, 0
L_lb_62:
  ds_read_b32 v15, v251 offset:8
  s_waitcnt lgkmcnt(0)
  v_readfirstlane_b32 s96, v15
  s_add_u32 s97, s97, 1
  s_cmp_ge_u32 s96, 4
  s_cbranch_scc1 L_lbd_63
  s_cmp_gt_u32 s97, 240000
  s_cbranch_scc1 L_lbd_63
  s_branch L_lb_62
L_lbd_63:
  s_waitcnt vmcnt(0)
  s_setprio 0
  s_lshl_b32 s83, s3, 11
  v_add_u32 v9, s83, v9
  s_mov_b32 s73, s72
  s_mov_b32 s77, 0
L_a_unit:
  s_sub_u32 s76, 8, s73
  s_cmp_gt_u32 s73, 8
  s_cselect_b32 s76, 0, s76
  s_cmp_lg_u32 s76, 0
  s_cbranch_scc1 L_a_slow
  v_mfma_f32_32x32x16_bf16 v[32:47], v[160:163], v[200:203], v[80:95]
  v_mfma_f32_32x32x16_bf16 v[48:63], v[164:167], v[200:203], 0
  s_mov_b64 exec, s[74:75]
  ds_read_b128 v[208:211], v9 offset:0
  ds_read_b128 v[212:215], v9 offset:512
  s_mov_b64 exec, -1
  v_pk_mov_b32 v[224:225], v[252:253], v[252:253] op_sel:[0,0]
  v_pk_mov_b32 v[226:227], v[252:253], v[252:253] op_sel:[0,0]
  v_pk_mov_b32 v[228:229], v[252:253], v[252:253] op_sel:[0,0]
  v_pk_mov_b32 v[230:231], v[252:253], v[252:253] op_sel:[0,0]
  v_pk_mov_b32 v[232:233], v[252:253], v[252:253] op_sel:[0,0]
  v_pk_mov_b32 v[234:235], v[252:253], v[252:253] op_sel:[0,0]
  v_pk_mov_b32 v[236:237], v[252:253], v[252:253] op_sel:[0,0]
  v_pk_mov_b32 v[238:239], v[252:253], v[252:253] op_sel:[0,0]
  v_mov_b32 v244, v240
  v_mov_b32 v246, v240
  v_mfma_f32_32x32x16_bf16 v[64:79], v[168:171], v[200:203], 0
  v_max3_f32 v244, v244, v32, v33
  v_max3_f32 v246, v246, v34, v35
  v_max3_f32 v244, v244, v36, v37
  v_max3_f32 v246, v246, v38, v39
  v_max3_f32 v244, v244, v40, v41
  v_max3_f32 v246, v246, v42, v43
  v_max3_f32 v244, v244, v44, v45
  v_max3_f32 v246, v246, v46, v47
  v_mfma_f32_32x32x16_bf16 v[32:47], v[172:175], v[200:203], 0
  v_max3_f32 v244, v244, v48, v49
  v_max3_f32 v246, v246, v50, v51
  v_max3_f32 v244, v244, v52, v53
  v_max3_f32 v246, v246, v54, v55
  v_max3_f32 v244, v244, v56, v57
  v_max3_f32 v246, v246, v58, v59
  v_max3_f32 v244, v244, v60, v61
  v_max3_f32 v246, v246, v62, v63
  v_mfma_f32_32x32x16_bf16 v[48:63], v[176:179], v[200:203], 0
  v_max3_f32 v244, v244, v64, v65
  v_max3_f32 v246, v246, v66, v67
  v_max3_f32 v244, v244, v68, v69
  v_max3_f32 v246, v246, v70, v71
  v_max3_f32 v244, v244, v72, v73
  v_max3_f32 v246, v246, v74, v75
  v_max3_f32 v244, v244, v76, v77
  v_max3_f32 v246, v246, v78, v79
  v_mfma_f32_32x32x16_bf16 v[64:79], v[180:183], v[200:203], 0
  v_max3_f32 v244, v244, v32, v33
  v_max3_f32 v246, v246, v34, v35
  v_max3_f32 v244, v244, v36, v37
  v_max3_f32 v246, v246, v38, v39
  v_max3_f32 v244, v244, v40, v41
  v_max3_f32 v246, v246, v42, v43
  v_max3_f32 v244, v244, v44, v45
  v_max3_f32 v246, v246, v46, v47
  v_mfma_f32_32x32x16_bf16 v[32:47], v[184:187], v[200:203], 0
  v_max3_f32 v244, v244, v48, v49
  v_max3_f32 v246, v246, v50, v51
  v_max3_f32 v244, v244, v52, v53
  v_max3_f32 v246, v246, v54, v55
  v_max3_f32 v244, v244, v56, v57
  v_max3_f32 v246, v246, v58, v59
  v_max3_f32 v244, v244, v60, v61
  v_max3_f32 v246, v246, v62, v63
  v_mfma_f32_32x32x16_bf16 v[48:63], v[188:191], v[200:203], 0
  v_max3_f32 v244, v244, v64, v65
  v_max3_f32 v246, v246, v66, v67
  v_max3_f32 v244, v244, v68, v69
  v_max3_f32 v246, v246, v70, v71
  v_max3_f32 v244, v244, v72, v73
  v_max3_f32 v246, v246, v74, v75
  v_max3_f32 v244, v244, v76, v77
  v_max3_f32 v246, v246, v78, v79
  v_mfma_f32_32x32x16_bf16 v[64:79], v[192:195], v[200:203], v[96:111]
  v_max3_f32 v244, v244, v32, v33
  v_max3_f32 v246, v246, v34, v35
  v_max3_f32 v244, v244, v36, v37
  v_max3_f32 v246, v246, v38, v39
  v_max3_f32 v244, v244, v40, v41
  v_max3_f32 v246, v246, v42, v43
  v_max3_f32 v244, v244, v44, v45
  v_max3_f32 v246, v246, v46, v47
  s_nop 3
  v_max3_f32 v244, v244, v48, v49
  v_max3_f32 v246, v246, v50, v51
  v_max3_f32 v244, v244, v52, v53
  v_max3_f32 v246, v246, v54, v55
  v_max3_f32 v244, v244, v56, v57
  v_max3_f32 v246, v246, v58, v59
  v_max3_f32 v244, v244, v60, v61
  v_max3_f32 v246, v246, v62, v63
  s_nop 3
  v_max3_f32 v244, v244, v64, v65
  v_max3_f32 v246, v246, v66, v67
  v_max3_f32 v244, v244, v68, v69
  v_max3_f32 v246, v246, v70, v71
  v_max3_f32 v244, v244, v72, v73
  v_max3_f32 v246, v246, v74, v75
  v_max3_f32 v244, v244, v76, v77
  v_max3_f32 v246, v246, v78, v79
  v_max_f32 v244, v244, v246
  v_mov_b32 v246, v244
  s_nop 1
  v_permlane32_swap_b32 v244, v246
  s_nop 1
  v_max_f32 v244, v244, v246
  v_sub_f32 v244, 0, v244
  v_mov_b32 v245, v244
  v_pk_mov_b32 v[112:113], v[244:245], v[244:245] op_sel:[0,1]
  v_pk_mov_b32 v[114:115], v[244:245], v[244:245] op_sel:[0,1]
  v_pk_mov_b32 v[116:117], v[244:245], v[244:245] op_sel:[0,1]
  v_pk_mov_b32 v[118:119], v[244:245], v[244:245] op_sel:[0,1]
  v_pk_mov_b32 v[120:121], v[244:245], v[244:245] op_sel:[0,1]
  v_pk_mov_b32 v[122:123], v[244:245], v[244:245] op_sel:[0,1]
  v_pk_mov_b32 v[124:125], v[244:245], v[244:245] op_sel:[0,1]
  v_pk_mov_b32 v[126:127], v[244:245], v[244:245] op_sel:[0,1]
  v_pk_add_f32 v[128:129], v[80:81], v[244:245]
  v_pk_add_f32 v[130:131], v[82:83], v[244:245]
  v_pk_add_f32 v[132:133], v[84:85], v[244:245]
  v_pk_add_f32 v[134:135], v[86:87], v[244:245]
  v_pk_add_f32 v[136:137], v[88:89], v[244:245]
  v_pk_add_f32 v[138:139], v[90:91], v[244:245]
  v_pk_add_f32 v[140:141], v[92:93], v[244:245]
  v_pk_add_f32 v[142:143], v[94:95], v[244:245]
  s_nop 1
  v_mfma_f32_32x32x16_bf16 v[32:47], v[160:163], v[200:203], v[128:143]
  v_mfma_f32_32x32x16_bf16 v[48:63], v[164:167], v[200:203], v[112:127]
  v_pk_add_f32 v[144:145], v[96:97], v[244:245]
  v_pk_add_f32 v[146:147], v[98:99], v[244:245]
  v_pk_add_f32 v[148:149], v[100:101], v[244:245]
  v_pk_add_f32 v[150:151], v[102:103], v[244:245]
  v_pk_add_f32 v[152:153], v[104:105], v[244:245]
  v_pk_add_f32 v[154:155], v[106:107], v[244:245]
  v_pk_add_f32 v[156:157], v[108:109], v[244:245]
  v_pk_add_f32 v[158:159], v[110:111], v[244:245]
  s_nop 3
  v_exp_f32 v32, v32
  v_exp_f32 v33, v33
  v_exp_f32 v34, v34
  v_exp_f32 v35, v35
  v_mfma_f32_32x32x16_bf16 v[64:79], v[168:171], v[200:203], v[112:127]
  v_exp_f32 v36, v36
  v_exp_f32 v37, v37
  v_exp_f32 v38, v38
  v_exp_f32 v39, v39
  v_exp_f32 v40, v40
  v_exp_f32 v41, v41
  v_exp_f32 v42, v42
  v_exp_f32 v43, v43
  v_exp_f32 v44, v44
  v_exp_f32 v45, v45
  v_exp_f32 v46, v46
  v_exp_f32 v47, v47
  s_nop 0
  v_cvt_pk_bf16_f32 v32, v32, v33
  v_cvt_pk_bf16_f32 v33, v34, v35
  v_cvt_pk_bf16_f32 v34, v36, v37
  v_cvt_pk_bf16_f32 v35, v38, v39
  v_cvt_pk_bf16_f32 v36, v40, v41
  v_cvt_pk_bf16_f32 v37, v42, v43
  v_cvt_pk_bf16_f32 v38, v44, v45
  v_cvt_pk_bf16_f32 v39, v46, v47
  v_exp_f32 v48, v48
  v_exp_f32 v49, v49
  s_waitcnt lgkmcnt(0)
  v_mfma_f32_32x32x16_bf16 v[224:239], v[208:211], v[32:35], v[224:239]
  v_exp_f32 v50, v50
  v_exp_f32 v51, v51
  v_exp_f32 v52, v52
  v_exp_f32 v53, v53
  v_exp_f32 v54, v54
  v_mfma_f32_32x32x16_bf16 v[224:239], v[212:215], v[36:39], v[224:239]
  s_mov_b64 exec, s[74:75]
  ds_read_b128 v[216:219], v9 offset:1024
  ds_read_b128 v[220:223], v9 offset:1536
  s_mov_b64 exec, -1
  v_exp_f32 v55, v55
  v_exp_f32 v56, v56
  v_exp_f32 v57, v57
  v_exp_f32 v58, v58
  v_exp_f32 v59, v59
  v_mfma_f32_32x32x16_bf16 v[32:47], v[172:175], v[200:203], v[112:127]
  v_exp_f32 v60, v60
  v_exp_f32 v61, v61
  v_exp_f32 v62, v62
  v_exp_f32 v63, v63
  s_nop 0
  v_cvt_pk_bf16_f32 v48, v48, v49
  v_cvt_pk_bf16_f32 v49, v50, v51
  v_cvt_pk_bf16_f32 v50, v52, v53
  v_cvt_pk_bf16_f32 v51, v54, v55
  v_cvt_pk_bf16_f32 v52, v56, v57
  v_cvt_pk_bf16_f32 v53, v58, v59
  v_cvt_pk_bf16_f32 v54, v60, v61
  v_cvt_pk_bf16_f32 v55, v62, v63
  v_exp_f32 v64, v64
  v_exp_f32 v65, v65
  s_waitcnt lgkmcnt(0)
  v_mfma_f32_32x32x16_bf16 v[224:239], v[216:219], v[48:51], v[224:239]
  v_exp_f32 v66, v66
  v_exp_f32 v67, v67
  v_exp_f32 v68, v68
  v_exp_f32 v69, v69
  v_exp_f32 v70, v70
  v_mfma_f32_32x32x16_bf16 v[224:239], v[220:223], v[52:55], v[224:239]
  s_mov_b64 exec, s[74:75]
  ds_read_b128 v[208:211], v9 offset:2048
  ds_read_b128 v[212:215], v9 offset:2560
  s_mov_b64 exec, -1
  v_exp_f32 v71, v71
  v_exp_f32 v72, v72
  v_exp_f32 v73, v73
  v_exp_f32 v74, v74
  v_exp_f32 v75, v75
  v_mfma_f32_32x32x16_bf16 v[48:63], v[176:179], v[200:203], v[112:127]
  v_exp_f32 v76, v76
  v_exp_f32 v77, v77
  v_exp_f32 v78, v78
  v_exp_f32 v79, v79
  s_nop 0
  v_cvt_pk_bf16_f32 v64, v64, v65
  v_cvt_pk_bf16_f32 v65, v66, v67
  v_cvt_pk_bf16_f32 v66, v68, v69
  v_cvt_pk_bf16_f32 v67, v70, v71
  v_cvt_pk_bf16_f32 v68, v72, v73
  v_cvt_pk_bf16_f32 v69, v74, v75
  v_cvt_pk_bf16_f32 v70, v76, v77
  v_cvt_pk_bf16_f32 v71, v78, v79
  v_exp_f32 v32, v32
  v_exp_f32 v33, v33
  s_waitcnt lgkmcnt(0)
  v_mfma_f32_32x32x16_bf16 v[224:239], v[208:211], v[64:67], v[224:239]
  v_exp_f32 v34, v34
  v_exp_f32 v35, v35
  v_exp_f32 v36, v36
  v_exp_f32 v37, v37
  v_exp_f32 v38, v38
  v_mfma_f32_32x32x16_bf16 v[224:239], v[212:215], v[68:71], v[224:239]
  s_mov_b64 exec, s[74:75]
  ds_read_b128 v[216:219], v9 offset:3072
  ds_read_b128 v[220:223], v9 offset:3584
  s_mov_b64 exec, -1
  v_exp_f32 v39, v39
  v_exp_f32 v40, v40
  v_exp_f32 v41, v41
  v_exp_f32 v42, v42
  v_exp_f32 v43, v43
  v_mfma_f32_32x32x16_bf16 v[64:79], v[180:183], v[200:203], v[112:127]
  v_exp_f32 v44, v44
  v_exp_f32 v45, v45
  v_exp_f32 v46, v46
  v_exp_f32 v47, v47
  s_nop 0
  v_cvt_pk_bf16_f32 v32, v32, v33
  v_cvt_pk_bf16_f32 v33, v34, v35
  v_cvt_pk_bf16_f32 v34, v36, v37
  v_cvt_pk_bf16_f32 v35, v38, v39
  v_cvt_pk_bf16_f32 v36, v40, v41
  v_cvt_pk_bf16_f32 v37, v42, v43
  v_cvt_pk_bf16_f32 v38, v44, v45
  v_cvt_pk_bf16_f32 v39, v46, v47
  v_exp_f32 v48, v48
  v_exp_f32 v49, v49
  s_waitcnt lgkmcnt(0)
  v_mfma_f32_32x32x16_bf16 v[224:239], v[216:219], v[32:35], v[224:239]
  v_exp_f32 v50, v50
  v_exp_f32 v51, v51
  v_exp_f32 v52, v52
  v_exp_f32 v53, v53
  v_exp_f32 v54, v54
  v_mfma_f32_32x32x16_bf16 v[224:239], v[220:223], v[36:39], v[224:239]
  s_mov_b64 exec, s[74:75]
  ds_read_b128 v[208:211], v9 offset:4096
  ds_read_b128 v[212:215], v9 offset:4608
  s_mov_b64 exec, -1
  v_exp_f32 v55, v55
  v_exp_f32 v56, v56
  v_exp_f32 v57, v57
  v_exp_f32 v58, v58
  v_exp_f32 v59, v59
  v_mfma_f32_32x32x16_bf16 v[32:47], v[184:187], v[200:203], v[112:127]
  v_exp_f32 v60, v60
  v_exp_f32 v61, v61
  v_exp_f32 v62, v62
  v_exp_f32 v63, v63
  s_nop 0
  v_cvt_pk_bf16_f32 v48, v48, v49
  v_cvt_pk_bf16_f32 v49, v50, v51
  v_cvt_pk_bf16_f32 v50, v52, v53
  v_cvt_pk_bf16_f32 v51, v54, v55
  v_cvt_pk_bf16_f32 v52, v56, v57
  v_cvt_pk_bf16_f32 v53, v58, v59
  v_cvt_pk_bf16_f32 v54, v60, v61
  v_cvt_pk_bf16_f32 v55, v62, v63
  v_exp_f32 v64, v64
  v_exp_f32 v65, v65
  s_waitcnt lgkmcnt(0)
  v_mfma_f32_32x32x16_bf16 v[224:239], v[208:211], v[48:51], v[224:239]
  v_exp_f32 v66, v66
  v_exp_f32 v67, v67
  v_exp_f32 v68, v68
  v_exp_f32 v69, v69
  v_exp_f32 v70, v70
  v_mfma_f32_32x32x16_bf16 v[224:239], v[212:215], v[52:55], v[224:239]
  s_mov_b64 exec, s[74:75]
  ds_read_b128 v[216:219], v9 offset:5120
  ds_read_b128 v[220:223], v9 offset:5632
  s_mov_b64 exec, -1
  v_exp_f32 v71, v71
  v_exp_f32 v72, v72
  v_exp_f32 v73, v73
  v_exp_f32 v74, v74
  v_exp_f32 v75, v75
  v_mfma_f32_32x32x16_bf16 v[48:63], v[188:191], v[200:203], v[112:127]
  v_exp_f32 v76, v76
  v_exp_f32 v77, v77
  v_exp_f32 v78, v78
  v_exp_f32 v79, v79
  s_nop 0
  v_cvt_pk_bf16_f32 v64, v64, v65
  v_cvt_pk_bf16_f32 v65, v66, v67
  v_cvt_pk_bf16_f32 v66, v68, v69
  v_cvt_pk_bf16_f32 v67, v70, v71
  v_cvt_pk_bf16_f32 v68, v72, v73
  v_cvt_pk_bf16_f32 v69, v74, v75
  v_cvt_pk_bf16_f32 v70, v76, v77
  v_cvt_pk_bf16_f32 v71, v78, v79
  v_exp_f32 v32, v32
  v_exp_f32 v33, v33
  s_waitcnt lgkmcnt(0)
  v_mfma_f32_32x32x16_bf16 v[224:239], v[216:219], v[64:67], v[224:239]
  v_exp_f32 v34, v34
  v_exp_f32 v35, v35
  v_exp_f32 v36, v36
  v_exp_f32 v37, v37
  v_exp_f32 v38, v38
  v_mfma_f32_32x32x16_bf16 v[224:239], v[220:223], v[68:71], v[224:239]
  s_mov_b64 exec, s[74:75]
  ds_read_b128 v[208:211], v9 offset:6144
  ds_read_b128 v[212:215], v9 offset:6656
  s_mov_b64 exec, -1
  v_exp_f32 v39, v39
  v_exp_f32 v40, v40
  v_exp_f32 v41, v41
  v_exp_f32 v42, v42
  v_exp_f32 v43, v43
  v_mfma_f32_32x32x16_bf16 v[64:79], v[192:195], v[200:203], v[144:159]
  v_exp_f32 v44, v44
  v_exp_f32 v45, v45
  v_exp_f32 v46, v46
  v_exp_f32 v47, v47
  s_nop 0
  v_cvt_pk_bf16_f32 v32, v32, v33
  v_cvt_pk_bf16_f32 v33, v34, v35
  v_cvt_pk_bf16_f32 v34, v36, v37
  v_cvt_pk_bf16_f32 v35, v38, v39
  v_cvt_pk_bf16_f32 v36, v40, v41
  v_cvt_pk_bf16_f32 v37, v42, v43
  v_cvt_pk_bf16_f32 v38, v44, v45
  v_cvt_pk_bf16_f32 v39, v46, v47
  v_exp_f32 v48, v48
  v_exp_f32 v49, v49
  s_waitcnt lgkmcnt(0)
  v_mfma_f32_32x32x16_bf16 v[224:239], v[208:211], v[32:35], v[224:239]
  v_exp_f32 v50, v50
  v_exp_f32 v51, v51
  v_exp_f32 v52, v52
  v_exp_f32 v53, v53
  v_exp_f32 v54, v54
  v_mfma_f32_32x32x16_bf16 v[224:239], v[212:215], v[36:39], v[224:239]
  s_mov_b64 exec, s[74:75]
  ds_read_b128 v[216:219], v9 offset:7168
  ds_read_b128 v[220:223], v9 offset:7680
  s_mov_b64 exec, -1
  v_exp_f32 v55, v55
  v_exp_f32 v56, v56
  v_exp_f32 v57, v57
  v_exp_f32 v58, v58
  v_exp_f32 v59, v59
  v_exp_f32 v60, v60
  v_exp_f32 v61, v61
  v_exp_f32 v62, v62
  v_exp_f32 v63, v63
  s_nop 0
  v_cvt_pk_bf16_f32 v48, v48, v49
  v_cvt_pk_bf16_f32 v49, v50, v51
  v_cvt_pk_bf16_f32 v50, v52, v53
  v_cvt_pk_bf16_f32 v51, v54, v55
  v_cvt_pk_bf16_f32 v52, v56, v57
  v_cvt_pk_bf16_f32 v53, v58, v59
  v_cvt_pk_bf16_f32 v54, v60, v61
  v_cvt_pk_bf16_f32 v55, v62, v63
  v_exp_f32 v64, v64
  v_exp_f32 v65, v65
  s_waitcnt lgkmcnt(0)
  v_mfma_f32_32x32x16_bf16 v[224:239], v[216:219], v[48:51], v[224:239]
  v_exp_f32 v66, v66
  v_exp_f32 v67, v67
  v_exp_f32 v68, v68
  v_exp_f32 v69, v69
  v_exp_f32 v70, v70
  v_mfma_f32_32x32x16_bf16 v[224:239], v[220:223], v[52:55], v[224:239]
  s_mov_b64 exec, s[74:75]
  ds_read_b128 v[208:211], v9 offset:8192
  ds_read_b128 v[212:215], v9 offset:8704
  s_mov_b64 exec, -1
  v_exp_f32 v71, v71
  v_exp_f32 v72, v72
  v_exp_f32 v73, v73
  v_exp_f32 v74, v74
  v_exp_f32 v75, v75
  v_exp_f32 v76, v76
  v_exp_f32 v77, v77
  v_exp_f32 v78, v78
  v_exp_f32 v79, v79
  s_nop 0
  v_cvt_pk_bf16_f32 v64, v64, v65
  v_cvt_pk_bf16_f32 v65, v66, v67
  v_cvt_pk_bf16_f32 v66, v68, v69
  v_cvt_pk_bf16_f32 v67, v70, v71
  v_cvt_pk_bf16_f32 v68, v72, v73
  v_cvt_pk_bf16_f32 v69, v74, v75
  v_cvt_pk_bf16_f32 v70, v76, v77
  v_cvt_pk_bf16_f32 v71, v78, v79
  s_waitcnt lgkmcnt(0)
  v_mfma_f32_32x32x16_bf16 v[224:239], v[208:211], v[64:67], v[224:239]
  v_mfma_f32_32x32x16_bf16 v[224:239], v[212:215], v[68:71], v[224:239]
L_a_join:
  v_pk_mov_b32 v[160:161], v[164:165], v[164:165] op_sel:[0,1]
  v_pk_mov_b32 v[162:163], v[166:167], v[166:167] op_sel:[0,1]
  v_pk_mov_b32 v[164:165], v[168:169], v[168:169] op_sel:[0,1]
  v_pk_mov_b32 v[166:167], v[170:171], v[170:171] op_sel:[0,1]
  v_pk_mov_b32 v[168:169], v[172:173], v[172:173] op_sel:[0,1]
  v_pk_mov_b32 v[170:171], v[174:175], v[174:175] op_sel:[0,1]
  v_pk_mov_b32 v[172:173], v[176:177], v[176:177] op_sel:[0,1]
  v_pk_mov_b32 v[174:175], v[178:179], v[178:179] op_sel:[0,1]
  v_pk_mov_b32 v[176:177], v[180:181], v[180:181] op_sel:[0,1]
  v_pk_mov_b32 v[178:179], v[182:183], v[182:183] op_sel:[0,1]
  v_pk_mov_b32 v[180:181], v[184:185], v[184:185] op_sel:[0,1]
  v_pk_mov_b32 v[182:183], v[186:187], v[186:187] op_sel:[0,1]
  v_pk_mov_b32 v[184:185], v[188:189], v[188:189] op_sel:[0,1]
  v_pk_mov_b32 v[186:187], v[190:191], v[190:191] op_sel:[0,1]
  v_pk_mov_b32 v[188:189], v[192:193], v[192:193] op_sel:[0,1]
  v_pk_mov_b32 v[190:191], v[194:195], v[194:195] op_sel:[0,1]
  v_pk_mov_b32 v[192:193], v[196:197], v[196:197] op_sel:[0,1]
  v_pk_mov_b32 v[194:195], v[198:199], v[198:199] op_sel:[0,1]
  v_pk_mov_b32 v[200:201], v[204:205], v[204:205] op_sel:[0,1]
  v_pk_mov_b32 v[202:203], v[206:207], v[206:207] op_sel:[0,1]
  v_add_u32 v9, 0x400, v9
  s_lshl_b32 s83, s73, 15
  v_rcp_f32 v10, v232
  s_nop 0
  v_mul_f32 v10, v10, v242
  v_mul_f32 v224, v224, v10
  v_mul_f32 v225, v225, v10
  v_mul_f32 v226, v226, v10
  v_mul_f32 v227, v227, v10
  v_mul_f32 v228, v228, v10
  v_mul_f32 v229, v229, v10
  v_mul_f32 v230, v230, v10
  v_mul_f32 v231, v231, v10
  s_cmp_eq_u32 s77, 0
  s_cbranch_scc0 L_a_unit2
  v_cvt_pk_bf16_f32 v12, v224, v225
  v_cvt_pk_bf16_f32 v13, v226, v227
  v_cvt_pk_bf16_f32 v14, v228, v229
  v_cvt_pk_bf16_f32 v15, v230, v231
  buffer_store_dwordx4 v[12:15], v7, s[12:15], s83 offen sc1
  v_mov_b32 v242, v243
  s_add_u32 s73, s73, 1
  s_mov_b32 s77, 1
  s_branch L_a_unit
L_a_unit2:
  v_cvt_pk_bf16_f32 v200, v224, v225
  v_cvt_pk_bf16_f32 v201, v226, v227
  v_cvt_pk_bf16_f32 v202, v228, v229
  v_cvt_pk_bf16_f32 v203, v230, v231
  buffer_store_dwordx4 v[200:203], v7, s[12:15], s83 offen sc1
  s_setprio 2
  s_lshl_b32 s83, s70, 5
  s_lshr_b32 s84, s72, 1
  s_add_u32 s83, s83, s84
  s_lshl_b32 s83, s83, 6
  s_add_u32 s83, s83, 0xd1c000
  v_mov_b32 v10, s68
  v_mov_b32 v11, s69
  s_waitcnt vmcnt(0)
  s_mov_b64 exec, 1
  buffer_store_dwordx2 v[10:11], v252, s[12:15], s83 offen sc1
  s_mov_b64 exec, -1
  s_endpgm
L_a_slow:
  s_cmp_gt_u32 s76, 0
  s_cbranch_scc1 L_inv_64
  v_mfma_f32_32x32x16_bf16 v[32:47], v[160:163], v[200:203], v[80:95]
  s_branch L_invd_65
L_inv_64:
  s_nop 7
  s_nop 7
  v_mov_b32 v32, v240
  v_mov_b32 v33, v240
  v_mov_b32 v34, v240
  v_mov_b32 v35, v240
  v_mov_b32 v36, v240
  v_mov_b32 v37, v240
  v_mov_b32 v38, v240
  v_mov_b32 v39, v240
  v_mov_b32 v40, v240
  v_mov_b32 v41, v240
  v_mov_b32 v42, v240
  v_mov_b32 v43, v240
  v_mov_b32 v44, v240
  v_mov_b32 v45, v240
  v_mov_b32 v46, v240
  v_mov_b32 v47, v240
L_invd_65:
  s_cmp_gt_u32 s76, 1
  s_cbranch_scc1 L_inv_66
  v_mfma_f32_32x32x16_bf16 v[48:63], v[164:167], v[200:203], 0
  s_branch L_invd_67
L_inv_66:
  s_nop 7
  s_nop 7
  v_mov_b32 v48, v240
  v_mov_b32 v49, v240
  v_mov_b32 v50, v240
  v_mov_b32 v51, v240
  v_mov_b32 v52, v240
  v_mov_b32 v53, v240
  v_mov_b32 v54, v240
  v_mov_b32 v55, v240
  v_mov_b32 v56, v240
  v_mov_b32 v57, v240
  v_mov_b32 v58, v240
  v_mov_b32 v59, v240
  v_mov_b32 v60, v240
  v_mov_b32 v61, v240
  v_mov_b32 v62, v240
  v_mov_b32 v63, v240
L_invd_67:
  s_mov_b64 exec, s[74:75]
  ds_read_b128 v[208:211], v9 offset:0
  ds_read_b128 v[212:215], v9 offset:512
  s_mov_b64 exec, -1
  v_pk_mov_b32 v[224:225], v[252:253], v[252:253] op_sel:[0,0]
  v_pk_mov_b32 v[226:227], v[252:253], v[252:253] op_sel:[0,0]
  v_pk_mov_b32 v[228:229], v[252:253], v[252:253] op_sel:[0,0]
  v_pk_mov_b32 v[230:231], v[252:253], v[252:253] op_sel:[0,0]
  v_pk_mov_b32 v[232:233], v[252:253], v[252:253] op_sel:[0,0]
  v_pk_mov_b32 v[234:235], v[252:253], v[252:253] op_sel:[0,0]
  v_pk_mov_b32 v[236:237], v[252:253], v[252:253] op_sel:[0,0]
  v_pk_mov_b32 v[238:239], v[252:253], v[252:253] op_sel:[0,0]
  v_mov_b32 v244, v240
  v_mov_b32 v246, v240
  s_cmp_gt_u32 s76, 2
  s_cbranch_scc1 L_inv_68
  v_mfma_f32_32x32x16_bf16 v[64:79], v[168:171], v[200:203], 0
  s_branch L_invd_69
L_inv_68:
  s_nop 7
  s_nop 7
  v_mov_b32 v64, v240
  v_mov_b32 v65, v240
  v_mov_b32 v66, v240
  v_mov_b32 v67, v240
  v_mov_b32 v68, v240
  v_mov_b32 v69, v240
  v_mov_b32 v70, v240
  v_mov_b32 v71, v240
  v_mov_b32 v72, v240
  v_mov_b32 v73, v240
  v_mov_b32 v74, v240
  v_mov_b32 v75, v240
  v_mov_b32 v76, v240
  v_mov_b32 v77, v240
  v_mov_b32 v78, v240
  v_mov_b32 v79, v240
L_invd_69:
  v_max3_f32 v244, v244, v32, v33
  v_max3_f32 v246, v246, v34, v35
  v_max3_f32 v244, v244, v36, v37
  v_max3_f32 v246, v246, v38, v39
  v_max3_f32 v244, v244, v40, v41
  v_max3_f32 v246, v246, v42, v43
  v_max3_f32 v244, v244, v44, v45
  v_max3_f32 v246, v246, v46, v47
  s_cmp_gt_u32 s76, 3
  s_cbranch_scc1 L_inv_70
  v_mfma_f32_32x32x16_bf16 v[32:47], v[172:175], v[200:203], 0
  s_branch L_invd_71
L_inv_70:
  s_nop 7
  s_nop 7
  v_mov_b32 v32, v240
  v_mov_b32 v33, v240
  v_mov_b32 v34, v240
  v_mov_b32 v35, v240
  v_mov_b32 v36, v240
  v_mov_b32 v37, v240
  v_mov_b32 v38, v240
  v_mov_b32 v39, v240
  v_mov_b32 v40, v240
  v_mov_b32 v41, v240
  v_mov_b32 v42, v240
  v_mov_b32 v43, v240
  v_mov_b32 v44, v240
  v_mov_b32 v45, v240
  v_mov_b32 v46, v240
  v_mov_b32 v47, v240
L_invd_71:
  v_max3_f32 v244, v244, v48, v49
  v_max3_f32 v246, v246, v50, v51
  v_max3_f32 v244, v244, v52, v53
  v_max3_f32 v246, v246, v54, v55
  v_max3_f32 v244, v244, v56, v57
  v_max3_f32 v246, v246, v58, v59
  v_max3_f32 v244, v244, v60, v61
  v_max3_f32 v246, v246, v62, v63
  s_cmp_gt_u32 s76, 4
  s_cbranch_scc1 L_inv_72
  v_mfma_f32_32x32x16_bf16 v[48:63], v[176:179], v[200:203], 0
  s_branch L_invd_73
L_inv_72:
  s_nop 7
  s_nop 7
  v_mov_b32 v48, v240
  v_mov_b32 v49, v240
  v_mov_b32 v50, v240
  v_mov_b32 v51, v240
  v_mov_b32 v52, v240
  v_mov_b32 v53, v240
  v_mov_b32 v54, v240
  v_mov_b32 v55, v240
  v_mov_b32 v56, v240
  v_mov_b32 v57, v240
  v_mov_b32 v58, v240
  v_mov_b32 v59, v240
  v_mov_b32 v60, v240
  v_mov_b32 v61, v240
  v_mov_b32 v62, v240
  v_mov_b32 v63, v240
L_invd_73:
  v_max3_f32 v244, v244, v64, v65
  v_max3_f32 v246, v246, v66, v67
  v_max3_f32 v244, v244, v68, v69
  v_max3_f32 v246, v246, v70, v71
  v_max3_f32 v244, v244, v72, v73
  v_max3_f32 v246, v246, v74, v75
  v_max3_f32 v244, v244, v76, v77
  v_max3_f32 v246, v246, v78, v79
  s_cmp_gt_u32 s76, 5
  s_cbranch_scc1 L_inv_74
  v_mfma_f32_32x32x16_bf16 v[64:79], v[180:183], v[200:203], 0
  s_branch L_invd_75
L_inv_74:
  s_nop 7
  s_nop 7
  v_mov_b32 v64, v240
  v_mov_b32 v65, v240
  v_mov_b32 v66, v240
  v_mov_b32 v67, v240
  v_mov_b32 v68, v240
  v_mov_b32 v69, v240
  v_mov_b32 v70, v240
  v_mov_b32 v71, v240
  v_mov_b32 v72, v240
  v_mov_b32 v73, v240
  v_mov_b32 v74, v240
  v_mov_b32 v75, v240
  v_mov_b32 v76, v240
  v_mov_b32 v77, v240
  v_mov_b32 v78, v240
  v_mov_b32 v79, v240
L_invd_75:
  v_max3_f32 v244, v244, v32, v33
  v_max3_f32 v246, v246, v34, v35
  v_max3_f32 v244, v244, v36, v37
  v_max3_f32 v246, v246, v38, v39
  v_max3_f32 v244, v244, v40, v41
  v_max3_f32 v246, v246, v42, v43
  v_max3_f32 v244, v244, v44, v45
  v_max3_f32 v246, v246, v46, v47
  s_cmp_gt_u32 s76, 6
  s_cbranch_scc1 L_inv_76
  v_mfma_f32_32x32x16_bf16 v[32:47], v[184:187], v[200:203], 0
  s_branch L_invd_77
L_inv_76:
  s_nop 7
  s_nop 7
  v_mov_b32 v32, v240
  v_mov_b32 v33, v240
  v_mov_b32 v34, v240
  v_mov_b32 v35, v240
  v_mov_b32 v36, v240
  v_mov_b32 v37, v240
  v_mov_b32 v38, v240
  v_mov_b32 v39, v240
  v_mov_b32 v40, v240
  v_mov_b32 v41, v240
  v_mov_b32 v42, v240
  v_mov_b32 v43, v240
  v_mov_b32 v44, v240
  v_mov_b32 v45, v240
  v_mov_b32 v46, v240
  v_mov_b32 v47, v240
L_invd_77:
  v_max3_f32 v244, v244, v48, v49
  v_max3_f32 v246, v246, v50, v51
  v_max3_f32 v244, v244, v52, v53
  v_max3_f32 v246, v246, v54, v55
  v_max3_f32 v244, v244, v56, v57
  v_max3_f32 v246, v246, v58, v59
  v_max3_f32 v244, v244, v60, v61
  v_max3_f32 v246, v246, v62, v63
  s_cmp_gt_u32 s76, 7
  s_cbranch_scc1 L_inv_78
  v_mfma_f32_32x32x16_bf16 v[48:63], v[188:191], v[200:203], 0
  s_branch L_invd_79
L_inv_78:
  s_nop 7
  s_nop 7
  v_mov_b32 v48, v240
  v_mov_b32 v49, v240
  v_mov_b32 v50, v240
  v_mov_b32 v51, v240
  v_mov_b32 v52, v240
  v_mov_b32 v53, v240
  v_mov_b32 v54, v240
  v_mov_b32 v55, v240
  v_mov_b32 v56, v240
  v_mov_b32 v57, v240
  v_mov_b32 v58, v240
  v_mov_b32 v59, v240
  v_mov_b32 v60, v240
  v_mov_b32 v61, v240
  v_mov_b32 v62, v240
  v_mov_b32 v63, v240
L_invd_79:
  v_max3_f32 v244, v244, v64, v65
  v_max3_f32 v246, v246, v66, v67
  v_max3_f32 v244, v244, v68, v69
  v_max3_f32 v246, v246, v70, v71
  v_max3_f32 v244, v244, v72, v73
  v_max3_f32 v246, v246, v74, v75
  v_max3_f32 v244, v244, v76, v77
  v_max3_f32 v246, v246, v78, v79
  v_mfma_f32_32x32x16_bf16 v[64:79], v[192:195], v[200:203], v[96:111]
  v_max3_f32 v244, v244, v32, v33
  v_max3_f32 v246, v246, v34, v35
  v_max3_f32 v244, v244, v36, v37
  v_max3_f32 v246, v246, v38, v39
  v_max3_f32 v244, v244, v40, v41
  v_max3_f32 v246, v246, v42, v43
  v_max3_f32 v244, v244, v44, v45
  v_max3_f32 v246, v246, v46, v47
  s_nop 3
  v_max3_f32 v244, v244, v48, v49
  v_max3_f32 v246, v246, v50, v51
  v_max3_f32 v244, v244, v52, v53
  v_max3_f32 v246, v246, v54, v55
  v_max3_f32 v244, v244, v56, v57
  v_max3_f32 v246, v246, v58, v59
  v_max3_f32 v244, v244, v60, v61
  v_max3_f32 v246, v246, v62, v63
  s_nop 3
  v_max3_f32 v244, v244, v64, v65
  v_max3_f32 v246, v246, v66, v67
  v_max3_f32 v244, v244, v68, v69
  v_max3_f32 v246, v246, v70, v71
  v_max3_f32 v244, v244, v72, v73
  v_max3_f32 v246, v246, v74, v75
  v_max3_f32 v244, v244, v76, v77
  v_max3_f32 v246, v246, v78, v79
  v_max_f32 v244, v244, v246
  v_mov_b32 v246, v244
  s_nop 1
  v_permlane32_swap_b32 v244, v246
  s_nop 1
  v_max_f32 v244, v244, v246
  v_sub_f32 v244, 0, v244
  v_mov_b32 v245, v244
  v_pk_mov_b32 v[112:113], v[244:245], v[244:245] op_sel:[0,1]
  v_pk_mov_b32 v[114:115], v[244:245], v[244:245] op_sel:[0,1]
  v_pk_mov_b32 v[116:117], v[244:245], v[244:245] op_sel:[0,1]
  v_pk_mov_b32 v[118:119], v[244:245], v[244:245] op_sel:[0,1]
  v_pk_mov_b32 v[120:121], v[244:245], v[244:245] op_sel:[0,1]
  v_pk_mov_b32 v[122:123], v[244:245], v[244:245] op_sel:[0,1]
  v_pk_mov_b32 v[124:125], v[244:245], v[244:245] op_sel:[0,1]
  v_pk_mov_b32 v[126:127], v[244:245], v[244:245] op_sel:[0,1]
  v_pk_add_f32 v[128:129], v[80:81], v[244:245]
  v_pk_add_f32 v[130:131], v[82:83], v[244:245]
  v_pk_add_f32 v[132:133], v[84:85], v[244:245]
  v_pk_add_f32 v[134:135], v[86:87], v[244:245]
  v_pk_add_f32 v[136:137], v[88:89], v[244:245]
  v_pk_add_f32 v[138:139], v[90:91], v[244:245]
  v_pk_add_f32 v[140:141], v[92:93], v[244:245]
  v_pk_add_f32 v[142:143], v[94:95], v[244:245]
  s_nop 1
  s_cmp_gt_u32 s76, 0
  s_cbranch_scc1 L_inv_80
  v_mfma_f32_32x32x16_bf16 v[32:47], v[160:163], v[200:203], v[128:143]
  s_branch L_invd_81
L_inv_80:
  s_nop 7
  s_nop 7
  v_mov_b32 v32, v240
  v_mov_b32 v33, v240
  v_mov_b32 v34, v240
  v_mov_b32 v35, v240
  v_mov_b32 v36, v240
  v_mov_b32 v37, v240
  v_mov_b32 v38, v240
  v_mov_b32 v39, v240
  v_mov_b32 v40, v240
  v_mov_b32 v41, v240
  v_mov_b32 v42, v240
  v_mov_b32 v43, v240
  v_mov_b32 v44, v240
  v_mov_b32 v45, v240
  v_mov_b32 v46, v240
  v_mov_b32 v47, v240
L_invd_81:
  s_cmp_gt_u32 s76, 1
  s_cbranch_scc1 L_inv_82
  v_mfma_f32_32x32x16_bf16 v[48:63], v[164:167], v[200:203], v[112:127]
  s_branch L_invd_83
L_inv_82:
  s_nop 7
  s_nop 7
  v_mov_b32 v48, v240
  v_mov_b32 v49, v240
  v_mov_b32 v50, v240
  v_mov_b32 v51, v240
  v_mov_b32 v52, v240
  v_mov_b32 v53, v240
  v_mov_b32 v54, v240
  v_mov_b32 v55, v240
  v_mov_b32 v56, v240
  v_mov_b32 v57, v240
  v_mov_b32 v58, v240
  v_mov_b32 v59, v240
  v_mov_b32 v60, v240
  v_mov_b32 v61, v240
  v_mov_b32 v62, v240
  v_mov_b32 v63, v240
L_invd_83:
  v_pk_add_f32 v[144:145], v[96:97], v[244:245]
  v_pk_add_f32 v[146:147], v[98:99], v[244:245]
  v_pk_add_f32 v[148:149], v[100:101], v[244:245]
  v_pk_add_f32 v[150:151], v[102:103], v[244:245]
  v_pk_add_f32 v[152:153], v[104:105], v[244:245]
  v_pk_add_f32 v[154:155], v[106:107], v[244:245]
  v_pk_add_f32 v[156:157], v[108:109], v[244:245]
  v_pk_add_f32 v[158:159], v[110:111], v[244:245]
  s_nop 3
  v_exp_f32 v32, v32
  v_exp_f32 v33, v33
  v_exp_f32 v34, v34
  v_exp_f32 v35, v35
  s_cmp_gt_u32 s76, 2
  s_cbranch_scc1 L_inv_84
  v_mfma_f32_32x32x16_bf16 v[64:79], v[168:171], v[200:203], v[112:127]
  s_branch L_invd_85
L_inv_84:
  s_nop 7
  s_nop 7
  v_mov_b32 v64, v240
  v_mov_b32 v65, v240
  v_mov_b32 v66, v240
  v_mov_b32 v67, v240
  v_mov_b32 v68, v240
  v_mov_b32 v69, v240
  v_mov_b32 v70, v240
  v_mov_b32 v71, v240
  v_mov_b32 v72, v240
  v_mov_b32 v73, v240
  v_mov_b32 v74, v240
  v_mov_b32 v75, v240
  v_mov_b32 v76, v240
  v_mov_b32 v77, v240
  v_mov_b32 v78, v240
  v_mov_b32 v79, v240
L_invd_85:
  v_exp_f32 v36, v36
  v_exp_f32 v37, v37
  v_exp_f32 v38, v38
  v_exp_f32 v39, v39
  v_exp_f32 v40, v40
  v_exp_f32 v41, v41
  v_exp_f32 v42, v42
  v_exp_f32 v43, v43
  v_exp_f32 v44, v44
  v_exp_f32 v45, v45
  v_exp_f32 v46, v46
  v_exp_f32 v47, v47
  s_nop 0
  v_cvt_pk_bf16_f32 v32, v32, v33
  v_cvt_pk_bf16_f32 v33, v34, v35
  v_cvt_pk_bf16_f32 v34, v36, v37
  v_cvt_pk_bf16_f32 v35, v38, v39
  v_cvt_pk_bf16_f32 v36, v40, v41
  v_cvt_pk_bf16_f32 v37, v42, v43
  v_cvt_pk_bf16_f32 v38, v44, v45
  v_cvt_pk_bf16_f32 v39, v46, v47
  v_exp_f32 v48, v48
  v_exp_f32 v49, v49
  s_waitcnt lgkmcnt(0)
  v_mfma_f32_32x32x16_bf16 v[224:239], v[208:211], v[32:35], v[224:239]
  v_exp_f32 v50, v50
  v_exp_f32 v51, v51
  v_exp_f32 v52, v52
  v_exp_f32 v53, v53
  v_exp_f32 v54, v54
  v_mfma_f32_32x32x16_bf16 v[224:239], v[212:215], v[36:39], v[224:239]
  s_mov_b64 exec, s[74:75]
  ds_read_b128 v[216:219], v9 offset:1024
  ds_read_b128 v[220:223], v9 offset:1536
  s_mov_b64 exec, -1
  v_exp_f32 v55, v55
  v_exp_f32 v56, v56
  v_exp_f32 v57, v57
  v_exp_f32 v58, v58
  v_exp_f32 v59, v59
  s_cmp_gt_u32 s76, 3
  s_cbranch_scc1 L_inv_86
  v_mfma_f32_32x32x16_bf16 v[32:47], v[172:175], v[200:203], v[112:127]
  s_branch L_invd_87
L_inv_86:
  s_nop 7
  s_nop 7
  v_mov_b32 v32, v240
  v_mov_b32 v33, v240
  v_mov_b32 v34, v240
  v_mov_b32 v35, v240
  v_mov_b32 v36, v240
  v_mov_b32 v37, v240
  v_mov_b32 v38, v240
  v_mov_b32 v39, v240
  v_mov_b32 v40, v240
  v_mov_b32 v41, v240
  v_mov_b32 v42, v240
  v_mov_b32 v43, v240
  v_mov_b32 v44, v240
  v_mov_b32 v45, v240
  v_mov_b32 v46, v240
  v_mov_b32 v47, v240
L_invd_87:
  v_exp_f32 v60, v60
  v_exp_f32 v61, v61
  v_exp_f32 v62, v62
  v_exp_f32 v63, v63
  s_nop 0
  v_cvt_pk_bf16_f32 v48, v48, v49
  v_cvt_pk_bf16_f32 v49, v50, v51
  v_cvt_pk_bf16_f32 v50, v52, v53
  v_cvt_pk_bf16_f32 v51, v54, v55
  v_cvt_pk_bf16_f32 v52, v56, v57
  v_cvt_pk_bf16_f32 v53, v58, v59
  v_cvt_pk_bf16_f32 v54, v60, v61
  v_cvt_pk_bf16_f32 v55, v62, v63
  v_exp_f32 v64, v64
  v_exp_f32 v65, v65
  s_waitcnt lgkmcnt(0)
  v_mfma_f32_32x32x16_bf16 v[224:239], v[216:219], v[48:51], v[224:239]
  v_exp_f32 v66, v66
  v_exp_f32 v67, v67
  v_exp_f32 v68, v68
  v_exp_f32 v69, v69
  v_exp_f32 v70, v70
  v_mfma_f32_32x32x16_bf16 v[224:239], v[220:223], v[52:55], v[224:239]
  s_mov_b64 exec, s[74:75]
  ds_read_b128 v[208:211], v9 offset:2048
  ds_read_b128 v[212:215], v9 offset:2560
  s_mov_b64 exec, -1
  v_exp_f32 v71, v71
  v_exp_f32 v72, v72
  v_exp_f32 v73, v73
  v_exp_f32 v74, v74
  v_exp_f32 v75, v75
  s_cmp_gt_u32 s76, 4
  s_cbranch_scc1 L_inv_88
  v_mfma_f32_32x32x16_bf16 v[48:63], v[176:179], v[200:203], v[112:127]
  s_branch L_invd_89
L_inv_88:
  s_nop 7
  s_nop 7
  v_mov_b32 v48, v240
  v_mov_b32 v49, v240
  v_mov_b32 v50, v240
  v_mov_b32 v51, v240
  v_mov_b32 v52, v240
  v_mov_b32 v53, v240
  v_mov_b32 v54, v240
  v_mov_b32 v55, v240
  v_mov_b32 v56, v240
  v_mov_b32 v57, v240
  v_mov_b32 v58, v240
  v_mov_b32 v59, v240
  v_mov_b32 v60, v240
  v_mov_b32 v61, v240
  v_mov_b32 v62, v240
  v_mov_b32 v63, v240
L_invd_89:
  v_exp_f32 v76, v76
  v_exp_f32 v77, v77
  v_exp_f32 v78, v78
  v_exp_f32 v79, v79
  s_nop 0
  v_cvt_pk_bf16_f32 v64, v64, v65
  v_cvt_pk_bf16_f32 v65, v66, v67
  v_cvt_pk_bf16_f32 v66, v68, v69
  v_cvt_pk_bf16_f32 v67, v70, v71
  v_cvt_pk_bf16_f32 v68, v72, v73
  v_cvt_pk_bf16_f32 v69, v74, v75
  v_cvt_pk_bf16_f32 v70, v76, v77
  v_cvt_pk_bf16_f32 v71, v78, v79
  v_exp_f32 v32, v32
  v_exp_f32 v33, v33
  s_waitcnt lgkmcnt(0)
  v_mfma_f32_32x32x16_bf16 v[224:239], v[208:211], v[64:67], v[224:239]
  v_exp_f32 v34, v34
  v_exp_f32 v35, v35
  v_exp_f32 v36, v36
  v_exp_f32 v37, v37
  v_exp_f32 v38, v38
  v_mfma_f32_32x32x16_bf16 v[224:239], v[212:215], v[68:71], v[224:239]
  s_mov_b64 exec, s[74:75]
  ds_read_b128 v[216:219], v9 offset:3072
  ds_read_b128 v[220:223], v9 offset:3584
  s_mov_b64 exec, -1
  v_exp_f32 v39, v39
  v_exp_f32 v40, v40
  v_exp_f32 v41, v41
  v_exp_f32 v42, v42
  v_exp_f32 v43, v43
  s_cmp_gt_u32 s76, 5
  s_cbranch_scc1 L_inv_90
  v_mfma_f32_32x32x16_bf16 v[64:79], v[180:183], v[200:203], v[112:127]
  s_branch L_invd_91
L_inv_90:
  s_nop 7
  s_nop 7
  v_mov_b32 v64, v240
  v_mov_b32 v65, v240
  v_mov_b32 v66, v240
  v_mov_b32 v67, v240
  v_mov_b32 v68, v240
  v_mov_b32 v69, v240
  v_mov_b32 v70, v240
  v_mov_b32 v71, v240
  v_mov_b32 v72, v240
  v_mov_b32 v73, v240
  v_mov_b32 v74, v240
  v_mov_b32 v75, v240
  v_mov_b32 v76, v240
  v_mov_b32 v77, v240
  v_mov_b32 v78, v240
  v_mov_b32 v79, v240
L_invd_91:
  v_exp_f32 v44, v44
  v_exp_f32 v45, v45
  v_exp_f32 v46, v46
  v_exp_f32 v47, v47
  s_nop 0
  v_cvt_pk_bf16_f32 v32, v32, v33
  v_cvt_pk_bf16_f32 v33, v34, v35
  v_cvt_pk_bf16_f32 v34, v36, v37
  v_cvt_pk_bf16_f32 v35, v38, v39
  v_cvt_pk_bf16_f32 v36, v40, v41
  v_cvt_pk_bf16_f32 v37, v42, v43
  v_cvt_pk_bf16_f32 v38, v44, v45
  v_cvt_pk_bf16_f32 v39, v46, v47
  v_exp_f32 v48, v48
  v_exp_f32 v49, v49
  s_waitcnt lgkmcnt(0)
  v_mfma_f32_32x32x16_bf16 v[224:239], v[216:219], v[32:35], v[224:239]
  v_exp_f32 v50, v50
  v_exp_f32 v51, v51
  v_exp_f32 v52, v52
  v_exp_f32 v53, v53
  v_exp_f32 v54, v54
  v_mfma_f32_32x32x16_bf16 v[224:239], v[220:223], v[36:39], v[224:239]
  s_mov_b64 exec, s[74:75]
  ds_read_b128 v[208:211], v9 offset:4096
  ds_read_b128 v[212:215], v9 offset:4608
  s_mov_b64 exec, -1
  v_exp_f32 v55, v55
  v_exp_f32 v56, v56
  v_exp_f32 v57, v57
  v_exp_f32 v58, v58
  v_exp_f32 v59, v59
  s_cmp_gt_u32 s76, 6
  s_cbranch_scc1 L_inv_92
  v_mfma_f32_32x32x16_bf16 v[32:47], v[184:187], v[200:203], v[112:127]
  s_branch L_invd_93
L_inv_92:
  s_nop 7
  s_nop 7
  v_mov_b32 v32, v240
  v_mov_b32 v33, v240
  v_mov_b32 v34, v240
  v_mov_b32 v35, v240
  v_mov_b32 v36, v240
  v_mov_b32 v37, v240
  v_mov_b32 v38, v240
  v_mov_b32 v39, v240
  v_mov_b32 v40, v240
  v_mov_b32 v41, v240
  v_mov_b32 v42, v240
  v_mov_b32 v43, v240
  v_mov_b32 v44, v240
  v_mov_b32 v45, v240
  v_mov_b32 v46, v240
  v_mov_b32 v47, v240
L_invd_93:
  v_exp_f32 v60, v60
  v_exp_f32 v61, v61
  v_exp_f32 v62, v62
  v_exp_f32 v63, v63
  s_nop 0
  v_cvt_pk_bf16_f32 v48, v48, v49
  v_cvt_pk_bf16_f32 v49, v50, v51
  v_cvt_pk_bf16_f32 v50, v52, v53
  v_cvt_pk_bf16_f32 v51, v54, v55
  v_cvt_pk_bf16_f32 v52, v56, v57
  v_cvt_pk_bf16_f32 v53, v58, v59
  v_cvt_pk_bf16_f32 v54, v60, v61
  v_cvt_pk_bf16_f32 v55, v62, v63
  v_exp_f32 v64, v64
  v_exp_f32 v65, v65
  s_waitcnt lgkmcnt(0)
  v_mfma_f32_32x32x16_bf16 v[224:239], v[208:211], v[48:51], v[224:239]
  v_exp_f32 v66, v66
  v_exp_f32 v67, v67
  v_exp_f32 v68, v68
  v_exp_f32 v69, v69
  v_exp_f32 v70, v70
  v_mfma_f32_32x32x16_bf16 v[224:239], v[212:215], v[52:55], v[224:239]
  s_mov_b64 exec, s[74:75]
  ds_read_b128 v[216:219], v9 offset:5120
  ds_read_b128 v[220:223], v9 offset:5632
  s_mov_b64 exec, -1
  v_exp_f32 v71, v71
  v_exp_f32 v72, v72
  v_exp_f32 v73, v73
  v_exp_f32 v74, v74
  v_exp_f32 v75, v75
  s_cmp_gt_u32 s76, 7
  s_cbranch_scc1 L_inv_94
  v_mfma_f32_32x32x16_bf16 v[48:63], v[188:191], v[200:203], v[112:127]
  s_branch L_invd_95
L_inv_94:
  s_nop 7
  s_nop 7
  v_mov_b32 v48, v240
  v_mov_b32 v49, v240
  v_mov_b32 v50, v240
  v_mov_b32 v51, v240
  v_mov_b32 v52, v240
  v_mov_b32 v53, v240
  v_mov_b32 v54, v240
  v_mov_b32 v55, v240
  v_mov_b32 v56, v240
  v_mov_b32 v57, v240
  v_mov_b32 v58, v240
  v_mov_b32 v59, v240
  v_mov_b32 v60, v240
  v_mov_b32 v61, v240
  v_mov_b32 v62, v240
  v_mov_b32 v63, v240
L_invd_95:
  v_exp_f32 v76, v76
  v_exp_f32 v77, v77
  v_exp_f32 v78, v78
  v_exp_f32 v79, v79
  s_nop 0
  v_cvt_pk_bf16_f32 v64, v64, v65
  v_cvt_pk_bf16_f32 v65, v66, v67
  v_cvt_pk_bf16_f32 v66, v68, v69
  v_cvt_pk_bf16_f32 v67, v70, v71
  v_cvt_pk_bf16_f32 v68, v72, v73
  v_cvt_pk_bf16_f32 v69, v74, v75
  v_cvt_pk_bf16_f32 v70, v76, v77
  v_cvt_pk_bf16_f32 v71, v78, v79
  v_exp_f32 v32, v32
  v_exp_f32 v33, v33
  s_waitcnt lgkmcnt(0)
  v_mfma_f32_32x32x16_bf16 v[224:239], v[216:219], v[64:67], v[224:239]
  v_exp_f32 v34, v34
  v_exp_f32 v35, v35
  v_exp_f32 v36, v36
  v_exp_f32 v37, v37
  v_exp_f32 v38, v38
  v_mfma_f32_32x32x16_bf16 v[224:239], v[220:223], v[68:71], v[224:239]
  s_mov_b64 exec, s[74:75]
  ds_read_b128 v[208:211], v9 offset:6144
  ds_read_b128 v[212:215], v9 offset:6656
  s_mov_b64 exec, -1
  v_exp_f32 v39, v39
  v_exp_f32 v40, v40
  v_exp_f32 v41, v41
  v_exp_f32 v42, v42
  v_exp_f32 v43, v43
  v_mfma_f32_32x32x16_bf16 v[64:79], v[192:195], v[200:203], v[144:159]
  v_exp_f32 v44, v44
  v_exp_f32 v45, v45
  v_exp_f32 v46, v46
  v_exp_f32 v47, v47
  s_nop 0
  v_cvt_pk_bf16_f32 v32, v32, v33
  v_cvt_pk_bf16_f32 v33, v34, v35
  v_cvt_pk_bf16_f32 v34, v36, v37
  v_cvt_pk_bf16_f32 v35, v38, v39
  v_cvt_pk_bf16_f32 v36, v40, v41
  v_cvt_pk_bf16_f32 v37, v42, v43
  v_cvt_pk_bf16_f32 v38, v44, v45
  v_cvt_pk_bf16_f32 v39, v46, v47
  v_exp_f32 v48, v48
  v_exp_f32 v49, v49
  s_waitcnt lgkmcnt(0)
  v_mfma_f32_32x32x16_bf16 v[224:239], v[208:211], v[32:35], v[224:239]
  v_exp_f32 v50, v50
  v_exp_f32 v51, v51
  v_exp_f32 v52, v52
  v_exp_f32 v53, v53
  v_exp_f32 v54, v54
  v_mfma_f32_32x32x16_bf16 v[224:239], v[212:215], v[36:39], v[224:239]
  s_mov_b64 exec, s[74:75]
  ds_read_b128 v[216:219], v9 offset:7168
  ds_read_b128 v[220:223], v9 offset:7680
  s_mov_b64 exec, -1
  v_exp_f32 v55, v55
  v_exp_f32 v56, v56
  v_exp_f32 v57, v57
  v_exp_f32 v58, v58
  v_exp_f32 v59, v59
  v_exp_f32 v60, v60
  v_exp_f32 v61, v61
  v_exp_f32 v62, v62
  v_exp_f32 v63, v63
  s_nop 0
  v_cvt_pk_bf16_f32 v48, v48, v49
  v_cvt_pk_bf16_f32 v49, v50, v51
  v_cvt_pk_bf16_f32 v50, v52, v53
  v_cvt_pk_bf16_f32 v51, v54, v55
  v_cvt_pk_bf16_f32 v52, v56, v57
  v_cvt_pk_bf16_f32 v53, v58, v59
  v_cvt_pk_bf16_f32 v54, v60, v61
  v_cvt_pk_bf16_f32 v55, v62, v63
  v_exp_f32 v64, v64
  v_exp_f32 v65, v65
  s_waitcnt lgkmcnt(0)
  v_mfma_f32_32x32x16_bf16 v[224:239], v[216:219], v[48:51], v[224:239]
  v_exp_f32 v66, v66
  v_exp_f32 v67, v67
  v_exp_f32 v68, v68
  v_exp_f32 v69, v69
  v_exp_f32 v70, v70
  v_mfma_f32_32x32x16_bf16 v[224:239], v[220:223], v[52:55], v[224:239]
  s_mov_b64 exec, s[74:75]
  ds_read_b128 v[208:211], v9 offset:8192
  ds_read_b128 v[212:215], v9 offset:8704
  s_mov_b64 exec, -1
  v_exp_f32 v71, v71
  v_exp_f32 v72, v72
  v_exp_f32 v73, v73
  v_exp_f32 v74, v74
  v_exp_f32 v75, v75
  v_exp_f32 v76, v76
  v_exp_f32 v77, v77
  v_exp_f32 v78, v78
  v_exp_f32 v79, v79
  s_nop 0
  v_cvt_pk_bf16_f32 v64, v64, v65
  v_cvt_pk_bf16_f32 v65, v66, v67
  v_cvt_pk_bf16_f32 v66, v68, v69
  v_cvt_pk_bf16_f32 v67, v70, v71
  v_cvt_pk_bf16_f32 v68, v72, v73
  v_cvt_pk_bf16_f32 v69, v74, v75
  v_cvt_pk_bf16_f32 v70, v76, v77
  v_cvt_pk_bf16_f32 v71, v78, v79
  s_waitcnt lgkmcnt(0)
  v_mfma_f32_32x32x16_bf16 v[224:239], v[208:211], v[64:67], v[224:239]
  v_mfma_f32_32x32x16_bf16 v[224:239], v[212:215], v[68:71], v[224:239]
  s_branch L_a_join
L_end:
  s_endpgm
.section .rodata,"a"
.p2align 6
.amdhsa_kernel gated_mix__sliding_block__mixer_token_mlp__prompt_kernel
  .amdhsa_next_free_vgpr 256
  .amdhsa_next_free_sgpr 102
  .amdhsa_accum_offset 256
  .amdhsa_group_segment_fixed_size 0
  .amdhsa_kernarg_size 96
  .amdhsa_user_sgpr_count 2
  .amdhsa_user_sgpr_kernarg_segment_ptr 1
  .amdhsa_system_sgpr_workgroup_id_x 1
.end_amdhsa_kernel
```
